```python
import torch

def _softmax(x, axis=-1):
    return torch.softmax(x, dim=axis)
def _gelu(x):
    return torch.nn.functional.gelu(x, approximate="tanh")
def _silu(x):
    return torch.nn.functional.silu(x)
def _sigmoid(x):
    return torch.sigmoid(x)
def _layernorm(x, axis=-1, eps=1e-5):
    m = x.mean(dim=axis, keepdim=True)
    v = x.var(dim=axis, keepdim=True, unbiased=False)
    return (x - m) / torch.sqrt(v + eps)
def _scatter_add(tgt, idx, src, axis=0):
    return tgt.clone().index_add_(axis, idx, src)
def _segment_sum(src, seg, n):
    out = torch.zeros((n,) + src.shape[1:], dtype=src.dtype)
    return out.index_add_(0, seg, src)
def _pad(x, pw):
    flat = tuple(v for pair in reversed(pw) for v in pair)
    return torch.nn.functional.pad(x, flat)

kernel_name = 'parallel_sum__compressed_kv_cla__dense_activation_silu__decode'

def setup_inputs():

    _w = (lambda a: (lambda t: t.to(torch.bfloat16) if t.is_floating_point() else t)(torch.as_tensor(a)))
    def _A_setup():
        B, H, Sq, Sk, D, M = 2, 32, 1, 8192, 128, 576
        Dc = 4 * D
        return {
            "x": _w((lambda *s: torch.randn(*s, dtype=torch.bfloat16) * 0.05)(B, Sq, M)),
            "c_kv": _w((lambda *s: torch.randn(*s, dtype=torch.bfloat16) * 0.8)(B, Sk, Dc)),
            "w_q": _w((lambda *s: torch.randn(*s, dtype=torch.bfloat16) * 3.2)(M, H, D) * (M ** -0.5)),
            "w_uk": _w((lambda *s: torch.randn(*s, dtype=torch.bfloat16) * 3.2)(Dc, H, D) * (Dc ** -0.5)),
            "w_uv": _w((lambda *s: torch.randn(*s, dtype=torch.bfloat16) * 0.8)(Dc, H, D) * (Dc ** -0.5)),
            "w_o": _w((lambda *s: torch.randn(*s, dtype=torch.bfloat16) * 0.8)(H, D, M) * ((H * D) ** -0.5)),
        }
    _A_in = _A_setup()

    def _B_setup():
        B, S, D, F = 2, 1, 576, 4608
        return {
            "x": _w((lambda *s: torch.randn(*s, dtype=torch.bfloat16) * 0.05)(B, S, D)),
            "w1": _w((lambda *s: torch.randn(*s, dtype=torch.bfloat16) * 3.2)(D, F) * (D ** -0.5)),
            "w2": _w((lambda *s: torch.randn(*s, dtype=torch.bfloat16) * 0.2)(F, D) * (F ** -0.5)),
        }
    _B_in = _B_setup()

    return {
        "A_x": _A_in["x"],
        "A_c_kv": _A_in["c_kv"],
        "A_w_q": _A_in["w_q"],
        "A_w_uk": _A_in["w_uk"],
        "A_w_uv": _A_in["w_uv"],
        "A_w_o": _A_in["w_o"],
        "B_x": _B_in["x"],
        "B_w1": _B_in["w1"],
        "B_w2": _B_in["w2"],
    }

def reference(A_x, A_c_kv, A_w_q, A_w_uk, A_w_uv, A_w_o, B_x, B_w1, B_w2):
    def _A_ref(x, c_kv, w_q, w_uk, w_uv, w_o):
        B, Sq, M = x.shape[0], x.shape[1], x.shape[2]
        Sk = c_kv.shape[1]
        H, D = w_q.shape[1], w_q.shape[2]
        q = torch.einsum("bqm,mhd->bhqd", x, w_q)
        k = torch.einsum("bkc,chd->bhkd", c_kv, w_uk)
        v = torch.einsum("bkc,chd->bhkd", c_kv, w_uv)
        scores = torch.einsum("bhqd,bhkd->bhqk", q, k) * (D ** -0.5)
        off = Sk - Sq
        qi = torch.arange(Sq)[:, None]
        kj = torch.arange(Sk)[None, :]
        cmask = kj <= (qi + off)
        scores = torch.where(cmask[None, None], scores, -1e9)
        p = _softmax(scores, axis=-1)
        ctx = torch.einsum("bhqk,bhkd->bhqd", p, v)
        return torch.einsum("bhqd,hdm->bqm", ctx, w_o)

    def _B_ref(x, w1, w2):
        h = torch.einsum("bsd,df->bsf", x, w1)
        h = _silu(h)
        out = torch.einsum("bsf,fd->bsd", h, w2)
        return out

    x = A_x
    xn = _layernorm(x, axis=-1)
    return x + _A_ref(xn, A_c_kv, A_w_q, A_w_uk, A_w_uv, A_w_o) + _B_ref(xn, B_w1, B_w2)
```

```asm
; @launch grid=(256,1,1) block=(512,1,1) lds=155648
.amdgcn_target "amdgcn-amd-amdhsa--gfx950"
.text
.globl parallel_sum__compressed_kv_cla__dense_activation_silu__decode_kernel
.p2align 8
.type parallel_sum__compressed_kv_cla__dense_activation_silu__decode_kernel,@function
parallel_sum__compressed_kv_cla__dense_activation_silu__decode_kernel:
    s_cmp_ge_u32 s2, 256
    s_cbranch_scc1 L_exit
    s_load_dwordx16 s[4:19], s[0:1], 0
    s_load_dwordx8 s[20:27], s[0:1], 64
    v_lshrrev_b32 v9, 6, v0
    v_and_b32 v0, 63, v0
    v_and_b32 v1, 15, v0
    v_readfirstlane_b32 s3, v9
    v_lshrrev_b32 v2, 4, v0
    v_lshlrev_b32 v8, 4, v0
    s_and_b32 s38, s2, 7
    s_lshr_b32 s39, s2, 3
    s_lshr_b32 s42, s2, 6
    s_xor_b32 s42, s42, 2
    s_lshl2_add_u32 s40, s38, s42
    s_and_b32 s41, s39, 7
    s_mov_b32 s33, 4194304
    s_cmp_lt_u32 s3, 4
    s_cbranch_scc1 L_S
    v_bfe_u32 v9, v1, 1, 2
    v_and_b32 v10, 1, v1
    v_lshlrev_b32 v10, 4, v10
    s_mov_b32 s42, 0xffff
    v_cmp_eq_u32 vcc, 0, v9
    v_cmp_eq_u32_e64 s[96:97], 1, v9
    v_cmp_eq_u32_e64 s[98:99], 2, v9
    v_cmp_eq_u32_e64 s[100:101], 3, v9
    v_lshlrev_b32 v10, v10, s42
    v_cndmask_b32 v3, 0, v10, vcc
    v_cndmask_b32_e64 v4, 0, v10, s[96:97]
    v_cndmask_b32_e64 v5, 0, v10, s[98:99]
    v_cndmask_b32_e64 v6, 0, v10, s[100:101]
    s_mov_b32 s34, 0x07060500
    s_mov_b32 s35, 0x07060501
    s_mov_b32 s36, 0x07060502
    s_mov_b32 s37, 0x07060503
    v_mov_b32 v11, 0
    s_cmp_eq_u32 s3, 5
    s_cbranch_scc1 L_C1
    s_cmp_eq_u32 s3, 7
    s_cbranch_scc1 L_C3
    s_setprio 3
    v_lshrrev_b32 v12, 3, v1
    v_mul_u32_u24 v12, 1152, v12
    v_mad_u32_u24 v13, v2, 36, v12
    v_and_b32 v14, 7, v1
    s_movk_i32 s42, 144
    v_mad_u32_u24 v9, v14, s42, v13
    s_cmp_eq_u32 s3, 4
    s_cbranch_scc0 L_C2a
    s_mul_i32 s43, s41, 144
    v_add_u32 v10, s43, v13
    s_mov_b32 s42, 147456
    v_mul_lo_u32 v11, v2, s42
    v_lshl_add_u32 v11, v1, 4, v11
    s_mul_i32 s43, s41, 589824
    s_lshl_b32 s42, s40, 8
    s_add_u32 s43, s43, s42
    s_movk_i32 s96, 0x2000
    s_waitcnt lgkmcnt(0)
    s_load_dword s28, s[26:27], 0
    s_mov_b32 s48, s4
    s_and_b32 s49, s5, 0xffff
    s_mov_b32 s50, 2304
    s_mov_b32 s51, 0x00020000
    buffer_load_dwordx3 v[12:14], v9, s[48:51], 0 offen
    buffer_load_dwordx3 v[16:18], v9, s[48:51], 0 offen offset:12
    buffer_load_dwordx3 v[20:22], v9, s[48:51], 0 offen offset:24
    buffer_load_dwordx3 v[24:26], v10, s[48:51], 0 offen
    buffer_load_dwordx3 v[28:30], v10, s[48:51], 0 offen offset:12
    buffer_load_dwordx3 v[32:34], v10, s[48:51], 0 offen offset:24
    s_mov_b32 s52, s8
    s_and_b32 s53, s9, 0xffff
    s_mov_b32 s54, 4718592
    s_mov_b32 s55, 0x00020000
    s_mov_b32 s44, s26
    s_and_b32 s45, s27, 0xffff
    s_mov_b32 s46, 9437184
    s_mov_b32 s47, 0x00020000
    buffer_load_dwordx4 v[128:131], v11, s[52:55], s43 offen nt
    s_add_u32 s43, s43, s96
    buffer_load_dwordx4 v[132:135], v11, s[52:55], s43 offen nt
    s_add_u32 s43, s43, s96
    buffer_load_dwordx4 v[136:139], v11, s[52:55], s43 offen nt
    s_add_u32 s43, s43, s96
    buffer_load_dwordx4 v[140:143], v11, s[52:55], s43 offen nt
    s_add_u32 s43, s43, s96
    buffer_load_dwordx4 v[144:147], v11, s[52:55], s43 offen nt
    s_add_u32 s43, s43, s96
    buffer_load_dwordx4 v[148:151], v11, s[52:55], s43 offen nt
    s_add_u32 s43, s43, s96
    buffer_load_dwordx4 v[152:155], v11, s[52:55], s43 offen nt
    s_add_u32 s43, s43, s96
    buffer_load_dwordx4 v[156:159], v11, s[52:55], s43 offen nt
    s_add_u32 s43, s43, s96
    buffer_load_dwordx4 v[160:163], v11, s[52:55], s43 offen nt
    s_add_u32 s43, s43, s96
    buffer_load_dwordx4 v[164:167], v11, s[52:55], s43 offen nt
    s_add_u32 s43, s43, s96
    buffer_load_dwordx4 v[168:171], v11, s[52:55], s43 offen nt
    s_add_u32 s43, s43, s96
    buffer_load_dwordx4 v[172:175], v11, s[52:55], s43 offen nt
    s_add_u32 s43, s43, s96
    buffer_load_dwordx4 v[176:179], v11, s[52:55], s43 offen nt
    s_add_u32 s43, s43, s96
    buffer_load_dwordx4 v[180:183], v11, s[52:55], s43 offen nt
    s_add_u32 s43, s43, s96
    buffer_load_dwordx4 v[184:187], v11, s[52:55], s43 offen nt
    s_add_u32 s43, s43, s96
    buffer_load_dwordx4 v[188:191], v11, s[52:55], s43 offen nt
    s_add_u32 s43, s43, s96
    buffer_load_dwordx4 v[192:195], v11, s[52:55], s43 offen nt
    s_add_u32 s43, s43, s96
    buffer_load_dwordx4 v[196:199], v11, s[52:55], s43 offen nt
    s_barrier
    s_waitcnt vmcnt(21)
    s_branch L_LN
L_C2a:
    s_mul_i32 s97, s2, 10923
    s_lshr_b32 s97, s97, 16
    s_mul_i32 s98, s97, 6
    s_sub_u32 s98, s2, s98
    s_mul_i32 s43, s98, 192
    v_mad_u32_u24 v10, v2, 48, v12
    v_add_u32 v10, s43, v10
    s_mov_b32 s42, 221184
    v_mul_lo_u32 v11, v2, s42
    v_lshl_add_u32 v11, v1, 4, v11
    s_mul_i32 s43, s98, 884736
    s_lshl_b32 s42, s97, 8
    s_add_u32 s43, s43, s42
    s_movk_i32 s96, 9216
    s_cmp_lt_u32 s2, 216
    s_cbranch_scc0 L_C3
    s_waitcnt lgkmcnt(0)
    s_mov_b32 s1, s43
    s_load_dword s28, s[26:27], 0
    s_mov_b32 s48, s4
    s_and_b32 s49, s5, 0xffff
    s_mov_b32 s50, 2304
    s_mov_b32 s51, 0x00020000
    buffer_load_dwordx3 v[12:14], v9, s[48:51], 0 offen
    buffer_load_dwordx3 v[16:18], v9, s[48:51], 0 offen offset:12
    buffer_load_dwordx3 v[20:22], v9, s[48:51], 0 offen offset:24
    buffer_load_dwordx4 v[24:27], v10, s[48:51], 0 offen
    buffer_load_dwordx4 v[28:31], v10, s[48:51], 0 offen offset:16
    buffer_load_dwordx4 v[32:35], v10, s[48:51], 0 offen offset:32
    s_mov_b32 s52, s18
    s_and_b32 s53, s19, 0xffff
    s_mov_b32 s54, 5308416
    s_mov_b32 s55, 0x00020000
    s_mov_b32 s44, s26
    s_and_b32 s45, s27, 0xffff
    s_mov_b32 s46, 9437184
    s_mov_b32 s47, 0x00020000
    s_setprio 1
    s_barrier
    s_waitcnt vmcnt(3)
L_LN:
    v_lshlrev_b32 v36, 16, v12
    v_and_b32 v37, 0xffff0000, v12
    v_lshlrev_b32 v38, 16, v13
    v_and_b32 v39, 0xffff0000, v13
    v_lshlrev_b32 v40, 16, v14
    v_and_b32 v41, 0xffff0000, v14
    v_lshlrev_b32 v42, 16, v16
    v_and_b32 v43, 0xffff0000, v16
    v_lshlrev_b32 v44, 16, v17
    v_and_b32 v45, 0xffff0000, v17
    v_lshlrev_b32 v46, 16, v18
    v_and_b32 v47, 0xffff0000, v18
    v_lshlrev_b32 v48, 16, v20
    v_and_b32 v49, 0xffff0000, v20
    v_lshlrev_b32 v50, 16, v21
    v_and_b32 v51, 0xffff0000, v21
    v_lshlrev_b32 v52, 16, v22
    v_and_b32 v53, 0xffff0000, v22
    v_pk_add_f32 v[78:79], v[36:37], v[38:39]
    v_pk_add_f32 v[80:81], v[40:41], v[42:43]
    v_pk_add_f32 v[78:79], v[78:79], v[44:45]
    v_pk_add_f32 v[80:81], v[80:81], v[46:47]
    v_pk_add_f32 v[78:79], v[78:79], v[48:49]
    v_pk_add_f32 v[80:81], v[80:81], v[50:51]
    v_pk_add_f32 v[78:79], v[78:79], v[52:53]
    v_pk_add_f32 v[78:79], v[78:79], v[80:81]
    v_add_f32 v78, v78, v79
    s_nop 1
    v_add_f32_dpp v78, v78, v78 quad_perm:[1,0,3,2] row_mask:0xf bank_mask:0xf
    s_nop 1
    v_add_f32_dpp v78, v78, v78 quad_perm:[2,3,0,1] row_mask:0xf bank_mask:0xf
    s_nop 1
    v_add_f32_dpp v78, v78, v78 row_half_mirror row_mask:0xf bank_mask:0xf
    v_mov_b32 v79, v78
    s_nop 1
    v_permlane16_swap_b32 v78, v79
    v_add_f32 v78, v78, v79
    v_mov_b32 v79, v78
    s_nop 1
    v_permlane32_swap_b32 v78, v79
    v_add_f32 v78, v78, v79
    v_mul_f32 v82, 0x3ae38e39, v78
    v_pk_add_f32 v[36:37], v[36:37], v[82:83] op_sel_hi:[1,0] neg_lo:[0,1] neg_hi:[0,1]
    v_pk_add_f32 v[38:39], v[38:39], v[82:83] op_sel_hi:[1,0] neg_lo:[0,1] neg_hi:[0,1]
    v_pk_add_f32 v[40:41], v[40:41], v[82:83] op_sel_hi:[1,0] neg_lo:[0,1] neg_hi:[0,1]
    v_pk_add_f32 v[42:43], v[42:43], v[82:83] op_sel_hi:[1,0] neg_lo:[0,1] neg_hi:[0,1]
    v_pk_add_f32 v[44:45], v[44:45], v[82:83] op_sel_hi:[1,0] neg_lo:[0,1] neg_hi:[0,1]
    v_pk_add_f32 v[46:47], v[46:47], v[82:83] op_sel_hi:[1,0] neg_lo:[0,1] neg_hi:[0,1]
    v_pk_add_f32 v[48:49], v[48:49], v[82:83] op_sel_hi:[1,0] neg_lo:[0,1] neg_hi:[0,1]
    v_pk_add_f32 v[50:51], v[50:51], v[82:83] op_sel_hi:[1,0] neg_lo:[0,1] neg_hi:[0,1]
    v_pk_add_f32 v[52:53], v[52:53], v[82:83] op_sel_hi:[1,0] neg_lo:[0,1] neg_hi:[0,1]
    v_pk_mul_f32 v[78:79], v[36:37], v[36:37]
    v_pk_mul_f32 v[80:81], v[38:39], v[38:39]
    v_pk_fma_f32 v[78:79], v[40:41], v[40:41], v[78:79]
    v_pk_fma_f32 v[80:81], v[42:43], v[42:43], v[80:81]
    v_pk_fma_f32 v[78:79], v[44:45], v[44:45], v[78:79]
    v_pk_fma_f32 v[80:81], v[46:47], v[46:47], v[80:81]
    v_pk_fma_f32 v[78:79], v[48:49], v[48:49], v[78:79]
    v_pk_fma_f32 v[80:81], v[50:51], v[50:51], v[80:81]
    v_pk_fma_f32 v[78:79], v[52:53], v[52:53], v[78:79]
    v_pk_add_f32 v[78:79], v[78:79], v[80:81]
    v_add_f32 v78, v78, v79
    s_cmp_eq_u32 s3, 4
    s_cbranch_scc0 L_C2b
    s_waitcnt vmcnt(18)
    v_add_f32_dpp v78, v78, v78 quad_perm:[1,0,3,2] row_mask:0xf bank_mask:0xf
    s_nop 1
    v_add_f32_dpp v78, v78, v78 quad_perm:[2,3,0,1] row_mask:0xf bank_mask:0xf
    s_nop 1
    v_add_f32_dpp v78, v78, v78 row_half_mirror row_mask:0xf bank_mask:0xf
    v_lshlrev_b32 v54, 16, v24
    v_and_b32 v55, 0xffff0000, v24
    v_lshlrev_b32 v56, 16, v25
    v_and_b32 v57, 0xffff0000, v25
    v_lshlrev_b32 v58, 16, v26
    v_and_b32 v59, 0xffff0000, v26
    v_lshlrev_b32 v60, 16, v28
    v_and_b32 v61, 0xffff0000, v28
    v_lshlrev_b32 v62, 16, v29
    v_and_b32 v63, 0xffff0000, v29
    v_lshlrev_b32 v64, 16, v30
    v_and_b32 v65, 0xffff0000, v30
    v_lshlrev_b32 v66, 16, v32
    v_and_b32 v67, 0xffff0000, v32
    v_lshlrev_b32 v68, 16, v33
    v_and_b32 v69, 0xffff0000, v33
    v_lshlrev_b32 v70, 16, v34
    v_and_b32 v71, 0xffff0000, v34
    v_mov_b32 v79, v78
    s_nop 1
    v_permlane16_swap_b32 v78, v79
    v_add_f32 v78, v78, v79
    v_mov_b32 v79, v78
    s_nop 1
    v_permlane32_swap_b32 v78, v79
    v_add_f32 v78, v78, v79
    v_cvt_pk_bf16_f32 v84, 0, v82
    v_mul_f32 v78, 0x3ae38e39, v78
    v_cvt_pk_bf16_f32 v78, 0, v78
    v_add_f32 v78, 0x3727c5ac, v78
    v_cvt_pk_bf16_f32 v78, 0, v78
    v_sqrt_f32 v78, v78
    v_pk_add_f32 v[54:55], v[54:55], v[84:85] op_sel_hi:[1,0] neg_lo:[0,1] neg_hi:[0,1]
    v_cvt_pk_bf16_f32 v78, 0, v78
    v_pk_add_f32 v[56:57], v[56:57], v[84:85] op_sel_hi:[1,0] neg_lo:[0,1] neg_hi:[0,1]
    v_rcp_f32 v86, v78
    v_pk_add_f32 v[58:59], v[58:59], v[84:85] op_sel_hi:[1,0] neg_lo:[0,1] neg_hi:[0,1]
    v_pk_add_f32 v[60:61], v[60:61], v[84:85] op_sel_hi:[1,0] neg_lo:[0,1] neg_hi:[0,1]
    v_pk_add_f32 v[62:63], v[62:63], v[84:85] op_sel_hi:[1,0] neg_lo:[0,1] neg_hi:[0,1]
    v_pk_add_f32 v[64:65], v[64:65], v[84:85] op_sel_hi:[1,0] neg_lo:[0,1] neg_hi:[0,1]
    v_pk_add_f32 v[66:67], v[66:67], v[84:85] op_sel_hi:[1,0] neg_lo:[0,1] neg_hi:[0,1]
    v_pk_add_f32 v[68:69], v[68:69], v[84:85] op_sel_hi:[1,0] neg_lo:[0,1] neg_hi:[0,1]
    v_pk_add_f32 v[70:71], v[70:71], v[84:85] op_sel_hi:[1,0] neg_lo:[0,1] neg_hi:[0,1]
    v_cvt_pk_bf16_f32 v54, 0, v54
    v_cvt_pk_bf16_f32 v55, 0, v55
    v_cvt_pk_bf16_f32 v56, 0, v56
    v_cvt_pk_bf16_f32 v57, 0, v57
    v_cvt_pk_bf16_f32 v58, 0, v58
    v_cvt_pk_bf16_f32 v59, 0, v59
    v_cvt_pk_bf16_f32 v60, 0, v60
    v_cvt_pk_bf16_f32 v61, 0, v61
    v_cvt_pk_bf16_f32 v62, 0, v62
    v_cvt_pk_bf16_f32 v63, 0, v63
    v_cvt_pk_bf16_f32 v64, 0, v64
    v_cvt_pk_bf16_f32 v65, 0, v65
    v_cvt_pk_bf16_f32 v66, 0, v66
    v_cvt_pk_bf16_f32 v67, 0, v67
    v_cvt_pk_bf16_f32 v68, 0, v68
    v_cvt_pk_bf16_f32 v69, 0, v69
    v_cvt_pk_bf16_f32 v70, 0, v70
    v_cvt_pk_bf16_f32 v71, 0, v71
    v_pk_mul_f32 v[54:55], v[54:55], v[86:87] op_sel_hi:[1,0]
    v_pk_mul_f32 v[56:57], v[56:57], v[86:87] op_sel_hi:[1,0]
    v_pk_mul_f32 v[58:59], v[58:59], v[86:87] op_sel_hi:[1,0]
    v_pk_mul_f32 v[60:61], v[60:61], v[86:87] op_sel_hi:[1,0]
    v_pk_mul_f32 v[62:63], v[62:63], v[86:87] op_sel_hi:[1,0]
    v_pk_mul_f32 v[64:65], v[64:65], v[86:87] op_sel_hi:[1,0]
    v_pk_mul_f32 v[66:67], v[66:67], v[86:87] op_sel_hi:[1,0]
    v_pk_mul_f32 v[68:69], v[68:69], v[86:87] op_sel_hi:[1,0]
    v_pk_mul_f32 v[70:71], v[70:71], v[86:87] op_sel_hi:[1,0]
    v_cvt_pk_bf16_f32 v88, v54, v54
    v_cvt_pk_bf16_f32 v89, v55, v55
    v_cvt_pk_bf16_f32 v90, v56, v56
    v_cvt_pk_bf16_f32 v91, v57, v57
    v_cvt_pk_bf16_f32 v92, v58, v58
    v_cvt_pk_bf16_f32 v93, v59, v59
    v_cvt_pk_bf16_f32 v94, v60, v60
    v_cvt_pk_bf16_f32 v95, v61, v61
    v_cvt_pk_bf16_f32 v96, v62, v62
    v_cvt_pk_bf16_f32 v97, v63, v63
    v_cvt_pk_bf16_f32 v98, v64, v64
    v_cvt_pk_bf16_f32 v99, v65, v65
    v_cvt_pk_bf16_f32 v100, v66, v66
    v_cvt_pk_bf16_f32 v101, v67, v67
    v_cvt_pk_bf16_f32 v102, v68, v68
    v_cvt_pk_bf16_f32 v103, v69, v69
    v_cvt_pk_bf16_f32 v104, v70, v70
    v_cvt_pk_bf16_f32 v105, v71, v71
    s_waitcnt lgkmcnt(0)
    s_add_u32 s28, s28, 1
    s_mul_i32 s29, s28, 0x9E3779B1
    s_lshr_b32 s30, s29, 8
    s_lshr_b32 s31, s29, 16
    s_lshr_b32 s32, s29, 24
    v_mov_b32 v7, s29
    s_lshl3_add_u32 s42, s40, s41
    s_lshl_b32 s42, s42, 10
    s_add_u32 s42, s42, 65536
    v_mov_b32 v12, 153600
    v_mov_b32 v13, 1
    v_and_b32 v112, v88, v3
    v_and_b32 v113, v88, v4
    v_and_b32 v114, v88, v5
    v_and_b32 v115, v88, v6
    v_and_b32 v116, v89, v3
    v_and_b32 v117, v89, v4
    v_and_b32 v118, v89, v5
    v_and_b32 v119, v89, v6
    s_waitcnt vmcnt(15)
    v_mfma_f32_16x16x32_bf16 v[120:123], v[112:115], v[128:131], 0
    v_and_b32 v112, v90, v3
    v_and_b32 v113, v90, v4
    v_and_b32 v114, v90, v5
    v_and_b32 v115, v90, v6
    v_mfma_f32_16x16x32_bf16 v[120:123], v[116:119], v[132:135], v[120:123]
    v_and_b32 v116, v91, v3
    v_and_b32 v117, v91, v4
    v_and_b32 v118, v91, v5
    v_and_b32 v119, v91, v6
    v_mfma_f32_16x16x32_bf16 v[120:123], v[112:115], v[136:139], v[120:123]
    v_and_b32 v112, v92, v3
    v_and_b32 v113, v92, v4
    v_and_b32 v114, v92, v5
    v_and_b32 v115, v92, v6
    s_waitcnt vmcnt(12)
    v_mfma_f32_16x16x32_bf16 v[120:123], v[116:119], v[140:143], v[120:123]
    v_and_b32 v116, v93, v3
    v_and_b32 v117, v93, v4
    v_and_b32 v118, v93, v5
    v_and_b32 v119, v93, v6
    v_mfma_f32_16x16x32_bf16 v[120:123], v[112:115], v[144:147], v[120:123]
    v_and_b32 v112, v94, v3
    v_and_b32 v113, v94, v4
    v_and_b32 v114, v94, v5
    v_and_b32 v115, v94, v6
    v_mfma_f32_16x16x32_bf16 v[120:123], v[116:119], v[148:151], v[120:123]
    v_and_b32 v116, v95, v3
    v_and_b32 v117, v95, v4
    v_and_b32 v118, v95, v5
    v_and_b32 v119, v95, v6
    s_waitcnt vmcnt(9)
    v_mfma_f32_16x16x32_bf16 v[120:123], v[112:115], v[152:155], v[120:123]
    v_and_b32 v112, v96, v3
    v_and_b32 v113, v96, v4
    v_and_b32 v114, v96, v5
    v_and_b32 v115, v96, v6
    v_mfma_f32_16x16x32_bf16 v[120:123], v[116:119], v[156:159], v[120:123]
    v_and_b32 v116, v97, v3
    v_and_b32 v117, v97, v4
    v_and_b32 v118, v97, v5
    v_and_b32 v119, v97, v6
    v_mfma_f32_16x16x32_bf16 v[120:123], v[112:115], v[160:163], v[120:123]
    v_and_b32 v112, v98, v3
    v_and_b32 v113, v98, v4
    v_and_b32 v114, v98, v5
    v_and_b32 v115, v98, v6
    s_waitcnt vmcnt(6)
    v_mfma_f32_16x16x32_bf16 v[120:123], v[116:119], v[164:167], v[120:123]
    v_and_b32 v116, v99, v3
    v_and_b32 v117, v99, v4
    v_and_b32 v118, v99, v5
    v_and_b32 v119, v99, v6
    v_mfma_f32_16x16x32_bf16 v[120:123], v[112:115], v[168:171], v[120:123]
    v_and_b32 v112, v100, v3
    v_and_b32 v113, v100, v4
    v_and_b32 v114, v100, v5
    v_and_b32 v115, v100, v6
    v_mfma_f32_16x16x32_bf16 v[120:123], v[116:119], v[172:175], v[120:123]
    v_and_b32 v116, v101, v3
    v_and_b32 v117, v101, v4
    v_and_b32 v118, v101, v5
    v_and_b32 v119, v101, v6
    s_waitcnt vmcnt(3)
    v_mfma_f32_16x16x32_bf16 v[120:123], v[112:115], v[176:179], v[120:123]
    v_and_b32 v112, v102, v3
    v_and_b32 v113, v102, v4
    v_and_b32 v114, v102, v5
    v_and_b32 v115, v102, v6
    v_mfma_f32_16x16x32_bf16 v[120:123], v[116:119], v[180:183], v[120:123]
    v_and_b32 v116, v103, v3
    v_and_b32 v117, v103, v4
    v_and_b32 v118, v103, v5
    v_and_b32 v119, v103, v6
    v_mfma_f32_16x16x32_bf16 v[120:123], v[112:115], v[184:187], v[120:123]
    v_and_b32 v112, v104, v3
    v_and_b32 v113, v104, v4
    v_and_b32 v114, v104, v5
    v_and_b32 v115, v104, v6
    s_waitcnt vmcnt(0)
    v_mfma_f32_16x16x32_bf16 v[120:123], v[116:119], v[188:191], v[120:123]
    v_and_b32 v116, v105, v3
    v_and_b32 v117, v105, v4
    v_and_b32 v118, v105, v5
    v_and_b32 v119, v105, v6
    v_mfma_f32_16x16x32_bf16 v[120:123], v[112:115], v[192:195], v[120:123]
    s_nop 0
    v_mfma_f32_16x16x32_bf16 v[120:123], v[116:119], v[196:199], v[120:123]
    s_nop 7
    v_perm_b32 v120, v120, v7, s34
    v_perm_b32 v121, v121, v7, s35
    v_perm_b32 v122, v122, v7, s36
    v_perm_b32 v123, v123, v7, s37
    buffer_store_dwordx4 v[120:123], v8, s[44:47], s42 offen sc1
    s_waitcnt vmcnt(0)
    ds_write_b32 v12, v13
    s_branch L_setup
L_C2b:
    s_waitcnt vmcnt(0)
    v_add_f32_dpp v78, v78, v78 quad_perm:[1,0,3,2] row_mask:0xf bank_mask:0xf
    s_nop 1
    v_add_f32_dpp v78, v78, v78 quad_perm:[2,3,0,1] row_mask:0xf bank_mask:0xf
    s_nop 1
    v_add_f32_dpp v78, v78, v78 row_half_mirror row_mask:0xf bank_mask:0xf
    v_lshlrev_b32 v54, 16, v24
    v_and_b32 v55, 0xffff0000, v24
    v_lshlrev_b32 v56, 16, v25
    v_and_b32 v57, 0xffff0000, v25
    v_lshlrev_b32 v58, 16, v26
    v_and_b32 v59, 0xffff0000, v26
    v_lshlrev_b32 v60, 16, v27
    v_and_b32 v61, 0xffff0000, v27
    v_lshlrev_b32 v62, 16, v28
    v_and_b32 v63, 0xffff0000, v28
    v_lshlrev_b32 v64, 16, v29
    v_and_b32 v65, 0xffff0000, v29
    v_lshlrev_b32 v66, 16, v30
    v_and_b32 v67, 0xffff0000, v30
    v_lshlrev_b32 v68, 16, v31
    v_and_b32 v69, 0xffff0000, v31
    v_lshlrev_b32 v70, 16, v32
    v_and_b32 v71, 0xffff0000, v32
    v_lshlrev_b32 v72, 16, v33
    v_and_b32 v73, 0xffff0000, v33
    v_lshlrev_b32 v74, 16, v34
    v_and_b32 v75, 0xffff0000, v34
    v_lshlrev_b32 v76, 16, v35
    v_and_b32 v77, 0xffff0000, v35
    v_mov_b32 v79, v78
    s_nop 1
    v_permlane16_swap_b32 v78, v79
    v_add_f32 v78, v78, v79
    v_mov_b32 v79, v78
    s_nop 1
    v_permlane32_swap_b32 v78, v79
    v_add_f32 v78, v78, v79
    v_cvt_pk_bf16_f32 v84, 0, v82
    v_mul_f32 v78, 0x3ae38e39, v78
    v_cvt_pk_bf16_f32 v78, 0, v78
    v_add_f32 v78, 0x3727c5ac, v78
    v_cvt_pk_bf16_f32 v78, 0, v78
    v_sqrt_f32 v78, v78
    v_pk_add_f32 v[54:55], v[54:55], v[84:85] op_sel_hi:[1,0] neg_lo:[0,1] neg_hi:[0,1]
    v_cvt_pk_bf16_f32 v78, 0, v78
    v_pk_add_f32 v[56:57], v[56:57], v[84:85] op_sel_hi:[1,0] neg_lo:[0,1] neg_hi:[0,1]
    v_rcp_f32 v86, v78
    v_pk_add_f32 v[58:59], v[58:59], v[84:85] op_sel_hi:[1,0] neg_lo:[0,1] neg_hi:[0,1]
    v_pk_add_f32 v[60:61], v[60:61], v[84:85] op_sel_hi:[1,0] neg_lo:[0,1] neg_hi:[0,1]
    v_pk_add_f32 v[62:63], v[62:63], v[84:85] op_sel_hi:[1,0] neg_lo:[0,1] neg_hi:[0,1]
    v_pk_add_f32 v[64:65], v[64:65], v[84:85] op_sel_hi:[1,0] neg_lo:[0,1] neg_hi:[0,1]
    v_pk_add_f32 v[66:67], v[66:67], v[84:85] op_sel_hi:[1,0] neg_lo:[0,1] neg_hi:[0,1]
    v_pk_add_f32 v[68:69], v[68:69], v[84:85] op_sel_hi:[1,0] neg_lo:[0,1] neg_hi:[0,1]
    v_pk_add_f32 v[70:71], v[70:71], v[84:85] op_sel_hi:[1,0] neg_lo:[0,1] neg_hi:[0,1]
    v_pk_add_f32 v[72:73], v[72:73], v[84:85] op_sel_hi:[1,0] neg_lo:[0,1] neg_hi:[0,1]
    v_pk_add_f32 v[74:75], v[74:75], v[84:85] op_sel_hi:[1,0] neg_lo:[0,1] neg_hi:[0,1]
    v_pk_add_f32 v[76:77], v[76:77], v[84:85] op_sel_hi:[1,0] neg_lo:[0,1] neg_hi:[0,1]
    v_cvt_pk_bf16_f32 v54, 0, v54
    v_cvt_pk_bf16_f32 v55, 0, v55
    v_cvt_pk_bf16_f32 v56, 0, v56
    v_cvt_pk_bf16_f32 v57, 0, v57
    v_cvt_pk_bf16_f32 v58, 0, v58
    v_cvt_pk_bf16_f32 v59, 0, v59
    v_cvt_pk_bf16_f32 v60, 0, v60
    v_cvt_pk_bf16_f32 v61, 0, v61
    v_cvt_pk_bf16_f32 v62, 0, v62
    v_cvt_pk_bf16_f32 v63, 0, v63
    v_cvt_pk_bf16_f32 v64, 0, v64
    v_cvt_pk_bf16_f32 v65, 0, v65
    v_cvt_pk_bf16_f32 v66, 0, v66
    v_cvt_pk_bf16_f32 v67, 0, v67
    v_cvt_pk_bf16_f32 v68, 0, v68
    v_cvt_pk_bf16_f32 v69, 0, v69
    v_cvt_pk_bf16_f32 v70, 0, v70
    v_cvt_pk_bf16_f32 v71, 0, v71
    v_cvt_pk_bf16_f32 v72, 0, v72
    v_cvt_pk_bf16_f32 v73, 0, v73
    v_cvt_pk_bf16_f32 v74, 0, v74
    v_cvt_pk_bf16_f32 v75, 0, v75
    v_cvt_pk_bf16_f32 v76, 0, v76
    v_cvt_pk_bf16_f32 v77, 0, v77
    v_pk_mul_f32 v[54:55], v[54:55], v[86:87] op_sel_hi:[1,0]
    v_pk_mul_f32 v[56:57], v[56:57], v[86:87] op_sel_hi:[1,0]
    v_pk_mul_f32 v[58:59], v[58:59], v[86:87] op_sel_hi:[1,0]
    v_pk_mul_f32 v[60:61], v[60:61], v[86:87] op_sel_hi:[1,0]
    v_pk_mul_f32 v[62:63], v[62:63], v[86:87] op_sel_hi:[1,0]
    v_pk_mul_f32 v[64:65], v[64:65], v[86:87] op_sel_hi:[1,0]
    v_pk_mul_f32 v[66:67], v[66:67], v[86:87] op_sel_hi:[1,0]
    v_pk_mul_f32 v[68:69], v[68:69], v[86:87] op_sel_hi:[1,0]
    v_pk_mul_f32 v[70:71], v[70:71], v[86:87] op_sel_hi:[1,0]
    v_pk_mul_f32 v[72:73], v[72:73], v[86:87] op_sel_hi:[1,0]
    v_pk_mul_f32 v[74:75], v[74:75], v[86:87] op_sel_hi:[1,0]
    v_pk_mul_f32 v[76:77], v[76:77], v[86:87] op_sel_hi:[1,0]
    v_cvt_pk_bf16_f32 v88, v54, v54
    v_cvt_pk_bf16_f32 v89, v55, v55
    v_cvt_pk_bf16_f32 v90, v56, v56
    v_cvt_pk_bf16_f32 v91, v57, v57
    v_cvt_pk_bf16_f32 v92, v58, v58
    v_cvt_pk_bf16_f32 v93, v59, v59
    v_cvt_pk_bf16_f32 v94, v60, v60
    v_cvt_pk_bf16_f32 v95, v61, v61
    v_cvt_pk_bf16_f32 v112, v62, v62
    v_cvt_pk_bf16_f32 v113, v63, v63
    v_cvt_pk_bf16_f32 v114, v64, v64
    v_cvt_pk_bf16_f32 v115, v65, v65
    v_cvt_pk_bf16_f32 v116, v66, v66
    v_cvt_pk_bf16_f32 v117, v67, v67
    v_cvt_pk_bf16_f32 v118, v68, v68
    v_cvt_pk_bf16_f32 v119, v69, v69
    v_cvt_pk_bf16_f32 v120, v70, v70
    v_cvt_pk_bf16_f32 v121, v71, v71
    v_cvt_pk_bf16_f32 v122, v72, v72
    v_cvt_pk_bf16_f32 v123, v73, v73
    v_cvt_pk_bf16_f32 v124, v74, v74
    v_cvt_pk_bf16_f32 v125, v75, v75
    v_cvt_pk_bf16_f32 v126, v76, v76
    v_cvt_pk_bf16_f32 v127, v77, v77
    s_waitcnt lgkmcnt(0)
    s_add_u32 s28, s28, 1
    s_mul_i32 s29, s28, 0x9E3779B1
    s_lshr_b32 s30, s29, 8
    s_lshr_b32 s31, s29, 16
    s_lshr_b32 s32, s29, 24
    v_mov_b32 v7, s29
    s_lshl_b32 s42, s2, 10
    s_add_u32 s42, s42, 5505024
    s_branch L_setup
L_C3:
    s_cmp_eq_u32 s3, 7
    s_cbranch_scc0 L_nopf
    s_getpc_b64 s[96:97]
L_pc:
    s_sub_u32 s96, s96, L_pc-parallel_sum__compressed_kv_cla__dense_activation_silu__decode_kernel
    s_subb_u32 s97, s97, 0
    v_lshlrev_b32 v14, 6, v0
    v_mov_b32 v15, s97
    s_lshl_b32 s42, s39, 9
    v_add_u32 v14, s42, v14
    s_mov_b64 exec, 0xff
    v_min_u32 v16, L_codeend-parallel_sum__compressed_kv_cla__dense_activation_silu__decode_kernel-4, v14
    v_add_co_u32 v12, vcc, s96, v16
    s_nop 1
    v_addc_co_u32 v13, vcc, 0, v15, vcc
    global_load_dword v20, v[12:13], off
    s_mov_b64 exec, -1
L_nopf:
    s_waitcnt lgkmcnt(0)
    s_load_dword s28, s[26:27], 0
    s_mov_b32 s44, s26
    s_and_b32 s45, s27, 0xffff
    s_mov_b32 s46, 9437184
    s_mov_b32 s47, 0x00020000
    s_barrier
    s_waitcnt lgkmcnt(0)
    s_add_u32 s28, s28, 1
    s_mul_i32 s29, s28, 0x9E3779B1
    s_lshr_b32 s30, s29, 8
    s_lshr_b32 s31, s29, 16
    s_lshr_b32 s32, s29, 24
    v_mov_b32 v7, s29
    s_branch L_setup
L_C1:
    s_setprio 2
    v_lshrrev_b32 v24, 2, v1
    v_and_b32 v25, 3, v1
    v_lshl_add_u32 v24, v24, 3, v25
    v_lshlrev_b32 v24, 13, v24
    v_lshl_add_u32 v24, v2, 4, v24
    s_lshl_b32 s42, s41, 19
    s_lshl_b32 s43, s40, 8
    s_add_u32 s96, s42, s43
    s_add_u32 s97, s96, 32768
    s_add_u32 s98, s96, 262144
    s_add_u32 s99, s96, 294912
    s_waitcnt lgkmcnt(0)
    s_load_dword s28, s[26:27], 0
    s_mov_b32 s48, s10
    s_and_b32 s49, s11, 0xffff
    s_mov_b32 s50, 4194304
    s_mov_b32 s51, 0x00020000
    s_barrier
    buffer_load_dwordx4 v[128:131], v24, s[48:51], s96 offen nt
    buffer_load_dwordx4 v[132:135], v24, s[48:51], s96 offen offset:64 nt
    buffer_load_dwordx4 v[136:139], v24, s[48:51], s96 offen offset:128 nt
    buffer_load_dwordx4 v[140:143], v24, s[48:51], s96 offen offset:192 nt
    buffer_load_dwordx4 v[144:147], v24, s[48:51], s97 offen nt
    buffer_load_dwordx4 v[148:151], v24, s[48:51], s97 offen offset:64 nt
    buffer_load_dwordx4 v[152:155], v24, s[48:51], s97 offen offset:128 nt
    buffer_load_dwordx4 v[156:159], v24, s[48:51], s97 offen offset:192 nt
    buffer_load_dwordx4 v[160:163], v24, s[48:51], s98 offen nt
    buffer_load_dwordx4 v[164:167], v24, s[48:51], s98 offen offset:64 nt
    buffer_load_dwordx4 v[168:171], v24, s[48:51], s98 offen offset:128 nt
    buffer_load_dwordx4 v[172:175], v24, s[48:51], s98 offen offset:192 nt
    buffer_load_dwordx4 v[176:179], v24, s[48:51], s99 offen nt
    buffer_load_dwordx4 v[180:183], v24, s[48:51], s99 offen offset:64 nt
    buffer_load_dwordx4 v[184:187], v24, s[48:51], s99 offen offset:128 nt
    buffer_load_dwordx4 v[188:191], v24, s[48:51], s99 offen offset:192 nt
    s_mov_b32 s44, s26
    s_and_b32 s45, s27, 0xffff
    s_mov_b32 s46, 9437184
    s_mov_b32 s47, 0x00020000
    s_waitcnt lgkmcnt(0)
    s_add_u32 s28, s28, 1
    s_mul_i32 s29, s28, 0x9E3779B1
    s_lshr_b32 s30, s29, 8
    s_lshr_b32 s31, s29, 16
    s_lshr_b32 s32, s29, 24
    v_mov_b32 v7, s29
L_setup:
    s_sub_u32 s96, s3, 4
    v_lshrrev_b32 v30, 3, v1
    v_and_b32 v31, 7, v1
    v_lshrrev_b32 v32, 2, v0
    v_and_b32 v33, 3, v0
    v_mul_u32_u24 v34, 256, v32
    v_lshl_add_u32 v34, v33, 4, v34
    s_lshr_b32 s42, s38, 2
    s_and_b32 s43, s39, 1
    s_lshl1_add_u32 s42, s42, s43
    s_lshl2_add_u32 s42, s42, s96
    s_mul_i32 s42, s42, 8192
    s_add_u32 s42, s42, 393216
    v_add_u32 v192, s42, v34
    v_lshlrev_b32 v35, 1, v33
    v_xor_b32 v35, v35, v32
    v_lshlrev_b32 v35, 4, v35
    v_lshl_add_u32 v35, v33, 8, v35
    s_lshl_b32 s42, s96, 12
    s_add_u32 s42, s42, 135168
    v_add_u32 v193, s42, v35
    v_mov_b32 v194, 153600
    s_lshl_b32 s42, s96, 2
    v_add_u32 v195, s42, v194
    v_mov_b32 v196, 1
    v_and_b32 v32, 3, v1
    v_lshrrev_b32 v33, 2, v1
    v_lshl_add_u32 v32, v32, 4, v33
    v_lshlrev_b32 v32, 13, v32
    v_lshl_add_u32 v32, v2, 4, v32
    s_lshr_b32 s42, s41, 1
    s_lshl_b32 s42, s42, 4
    s_and_b32 s43, s41, 1
    s_add_u32 s42, s42, s43
    s_lshl_b32 s42, s42, 16
    s_lshl2_add_u32 s43, s40, s96
    s_lshl_b32 s43, s43, 6
    s_add_u32 s42, s42, s43
    v_add_u32 v197, s42, v32
    s_movk_i32 s42, 4608
    v_mul_lo_u32 v32, v2, s42
    v_lshl_add_u32 v32, v1, 4, v32
    v_mul_u32_u24 v33, 1152, v2
    v_lshl_add_u32 v33, v1, 4, v33
    s_cmp_eq_u32 s96, 3
    s_cselect_b32 s43, 8, 0
    v_cmp_gt_u32 vcc, s43, v1
    v_mov_b32 v34, 0x80000000
    s_lshl3_add_u32 s42, s40, s41
    s_mul_i32 s42, s42, 18432
    s_lshl_b32 s97, s96, 8
    s_add_u32 s98, s42, s97
    s_add_u32 s42, s42, 1024
    v_cndmask_b32 v34, v34, 0, vcc
    v_add_u32 v198, s98, v32
    v_add_u32 v199, s42, v32
    v_add_u32 v199, v199, v34
    s_lshr_b32 s99, s2, 1
    s_mul_i32 s99, s99, 36
    s_and_b32 s101, s2, 1
    s_mul_i32 s42, s101, 20
    s_add_u32 s99, s99, s42
    s_mul_i32 s42, s99, 1152
    s_add_u32 s98, s42, s97
    s_add_u32 s42, s42, 1024
    v_add_u32 v200, s98, v32
    v_add_u32 v202, s42, v32
    v_add_u32 v202, v202, v34
    s_lshl_b32 s43, s101, 31
    s_add_u32 s43, s43, 18432
    s_add_u32 s98, s98, s43
    s_add_u32 s42, s42, s43
    v_add_u32 v201, s98, v33
    v_add_u32 v203, s42, v33
    v_or_b32 v203, v203, v34
    s_mul_i32 s42, s2, 4608
    s_add_u32 s42, s42, 5767168
    s_lshl_b32 s43, s96, 10
    s_add_u32 s43, s43, s42
    v_add_u32 v218, s43, v8
    v_lshlrev_b32 v35, 3, v2
    v_add_lshl_u32 v35, v35, v1, 4
    s_add_u32 s42, s42, 0x1000
    v_add3_u32 v219, v35, s42, v34
    v_add_u32 v208, 151552, v8
    v_lshlrev_b32 v32, 2, v0
    v_add_u32 v209, 152576, v32
    s_sub_u32 s42, s2, 64
    s_cmp_lt_u32 s2, 64
    s_cbranch_scc0 L_hi72
    s_lshl_b32 s42, s2, 2
    s_and_b32 s42, s42, 15
    s_bfe_u32 s43, s2, 0x20002
    s_lshr_b32 s97, s2, 4
    s_branch L_j72
L_hi72:
    s_lshr_b32 s43, s42, 1
    s_and_b32 s43, s43, 3
    s_lshl_b32 s42, s42, 2
    s_and_b32 s42, s42, 7
    s_mov_b32 s97, 4
L_j72:
    s_lshl_b32 s97, s97, 7
    s_lshl3_add_u32 s97, s42, s97
    s_lshr_b32 s42, s43, 1
    s_mul_i32 s42, s42, 576
    s_add_u32 s97, s97, s42
    s_and_b32 s43, s43, 1
    s_lshl2_add_u32 s97, s43, s97
    v_and_b32 v32, 3, v1
    v_lshl_add_u32 v32, v32, 3, v2
    v_add_lshl_u32 v223, v32, s97, 1
    v_and_b32 v32, 0x3f803f80, v3
    v_and_b32 v33, 0x3f803f80, v4
    v_and_b32 v34, 0x3f803f80, v5
    v_and_b32 v35, 0x3f803f80, v6
    v_cmp_eq_u32 vcc, v30, v2
    v_add_u32 v36, 2, v30
    v_cmp_eq_u32_e64 s[98:99], v36, v2
    v_cndmask_b32 v228, 0, v32, vcc
    v_cndmask_b32 v229, 0, v33, vcc
    v_cndmask_b32 v230, 0, v34, vcc
    v_cndmask_b32 v231, 0, v35, vcc
    v_cndmask_b32_e64 v232, 0, v32, s[98:99]
    v_cndmask_b32_e64 v233, 0, v33, s[98:99]
    v_cndmask_b32_e64 v234, 0, v34, s[98:99]
    v_cndmask_b32_e64 v235, 0, v35, s[98:99]
    v_bfe_u32 v33, v1, 2, 1
    v_and_b32 v32, 3, v1
    v_lshl_add_u32 v32, v32, 2, v2
    s_lshr_b32 s42, s41, 1
    s_lshr_b32 s43, s40, 4
    s_lshl2_add_u32 s42, s43, s42
    s_lshl_b32 s42, s42, 15
    s_and_b32 s43, s40, 15
    s_lshl4_add_u32 s42, s43, s42
    s_add_u32 s42, s42, 524288
    v_xor_b32 v34, s96, v33
    v_lshl_add_u32 v34, v34, 4, v32
    v_lshlrev_b32 v34, 8, v34
    v_lshl_add_u32 v34, v30, 14, v34
    v_add_u32 v210, s42, v34
    v_xor_b32 v34, s96, v33
    v_xor_b32 v34, 2, v34
    v_lshl_add_u32 v34, v34, 4, v32
    v_lshlrev_b32 v34, 8, v34
    v_lshl_add_u32 v34, v30, 14, v34
    v_add_u32 v211, s42, v34
    s_lshl3_add_u32 s100, s40, s41
    s_lshl_b32 s42, s100, 14
    s_lshl_b32 s43, s96, 11
    s_add_u32 s42, s42, s43
    s_add_u32 s42, s42, 1048576
    v_lshlrev_b32 v33, 7, v2
    v_lshl_add_u32 v33, v30, 13, v33
    v_lshl_add_u32 v33, v31, 4, v33
    v_add_u32 v212, s42, v33
    s_lshl_b32 s42, s100, 10
    s_add_u32 s42, s42, 5242880
    v_lshlrev_b32 v35, 7, v31
    v_lshl_add_u32 v35, v30, 6, v35
    v_lshl_add_u32 v35, v2, 4, v35
    v_add_u32 v216, s42, v35
    s_lshl_b32 s42, s40, 13
    s_lshl_b32 s43, s96, 11
    s_add_u32 s42, s42, s43
    s_lshl_b32 s43, s41, 7
    s_add_u32 s42, s42, s43
    s_add_u32 s42, s42, 5242880
    v_bfe_u32 v33, v1, 2, 1
    v_lshlrev_b32 v36, 10, v30
    v_lshl_add_u32 v36, v33, 6, v36
    v_lshl_add_u32 v36, v2, 4, v36
    v_add_u32 v215, s42, v36
    v_lshrrev_b32 v32, 1, v2
    v_and_b32 v33, 1, v2
    v_lshlrev_b32 v34, 3, v33
    v_lshl_add_u32 v34, v1, 4, v34
    s_mul_i32 s42, s96, 288
    s_add_u32 s42, s42, 137216
    v_add_u32 v34, s42, v34
    v_cmp_eq_u32 vcc, v30, v32
    v_lshlrev_b32 v35, 3, v0
    v_add_u32 v35, 154560, v35
    v_cndmask_b32 v213, v35, v34, vcc
    v_and_b32 v34, 3, v1
    v_mul_u32_u24 v35, 288, v34
    v_bfe_u32 v36, v1, 2, 1
    v_lshl_add_u32 v35, v36, 7, v35
    v_lshl_add_u32 v35, v2, 4, v35
    v_add_u32 v214, 137216, v35
    v_lshlrev_b32 v34, 3, v34
    v_lshrrev_b32 v217, v34, v7
    v_lshrrev_b32 v32, 2, v0
    v_mul_u32_u24 v32, 4608, v32
    v_and_b32 v33, 3, v0
    v_lshl_add_u32 v32, v33, 4, v32
    s_mul_i32 s42, s96, 294912
    s_lshl_b32 s43, s2, 6
    s_add_u32 s42, s42, s43
    s_add_u32 s42, s42, 5767168
    v_add_u32 v220, s42, v32
    v_lshl_add_u32 v33, v2, 2, v33
    v_lshlrev_b32 v33, 2, v33
    v_add_u32 v222, 138752, v33
    s_lshl_b32 s42, s96, 6
    v_add_u32 v221, s42, v222
    s_mov_b32 s43, 0x9E3779B1
    s_lshl_b32 s42, s96, 4
    v_add_u32 v32, s42, v2
    v_and_b32 v33, 3, v1
    v_lshlrev_b32 v33, 2, v33
    v_mul_lo_u32 v34, v32, s43
    v_xor_b32 v34, v34, v7
    v_lshrrev_b32 v236, v33, v34
    v_add_u32 v32, 4, v32
    v_lshrrev_b32 v237, 1, v236
    v_lshrrev_b32 v238, 2, v236
    v_lshrrev_b32 v239, 3, v236
    v_mul_lo_u32 v34, v32, s43
    v_xor_b32 v34, v34, v7
    v_lshrrev_b32 v240, v33, v34
    v_add_u32 v32, 4, v32
    v_lshrrev_b32 v241, 1, v240
    v_lshrrev_b32 v242, 2, v240
    v_lshrrev_b32 v243, 3, v240
    v_mul_lo_u32 v34, v32, s43
    v_xor_b32 v34, v34, v7
    v_lshrrev_b32 v244, v33, v34
    v_add_u32 v32, 4, v32
    v_lshrrev_b32 v245, 1, v244
    v_lshrrev_b32 v246, 2, v244
    v_lshrrev_b32 v247, 3, v244
    v_mul_lo_u32 v34, v32, s43
    v_xor_b32 v34, v34, v7
    v_lshrrev_b32 v248, v33, v34
    v_lshrrev_b32 v249, 1, v248
    v_lshrrev_b32 v250, 2, v248
    v_lshrrev_b32 v251, 3, v248
    v_lshlrev_b32 v253, 3, v31
    v_add_u32 v253, 155584, v253
    s_lshl_b32 s42, s96, 3
    s_add_u32 s42, s42, 155584
    v_lshlrev_b32 v252, 5, v30
    v_add_u32 v252, s42, v252
    s_mov_b32 s56, s4
    s_and_b32 s57, s5, 0xffff
    s_mov_b32 s58, 2304
    s_mov_b32 s59, 0x00020000
    s_mov_b32 s60, s22
    s_and_b32 s61, s23, 0xffff
    s_mov_b32 s62, 2304
    s_mov_b32 s63, 0x00020000
    s_cmp_eq_u32 s96, 1
    s_cbranch_scc1 L_C1b
L_E1:
    s_mov_b32 s48, s12
    s_and_b32 s49, s13, 0xffff
    s_mov_b32 s50, 4194304
    s_mov_b32 s51, 0x00020000
    s_mov_b32 s52, s20
    s_and_b32 s53, s21, 0xffff
    s_mov_b32 s54, 5308416
    s_mov_b32 s55, 0x00020000
    s_movk_i32 s42, 4096
L_gi:
    s_sub_u32 s33, s33, 1
    s_cbranch_scc1 L_timeout
    ds_read_b128 v[32:35], v194 offset:64
    s_waitcnt lgkmcnt(0)
    v_and_b32 v32, v32, v33
    v_bitop3_b32 v32, v32, v34, v35 bitop3:0x80
    v_cmp_eq_u32 vcc, 0, v32
    s_cbranch_vccnz L_gi
L_gq1:
    s_sub_u32 s33, s33, 1
    s_cbranch_scc1 L_timeout
    ds_read_b32 v32, v194 offset:4
    s_waitcnt lgkmcnt(0)
    v_cmp_eq_u32 vcc, 0, v32
    s_cbranch_vccnz L_gq1
L_e1:
    s_sub_u32 s33, s33, 64
    s_cbranch_scc1 L_timeout
    buffer_load_dwordx4 v[64:67], v192, s[44:47], 0 offen sc1
    buffer_load_dwordx4 v[68:71], v192, s[44:47], 0 offen offset:64 sc1
    buffer_load_dwordx4 v[72:75], v192, s[44:47], 0 offen offset:128 sc1
    buffer_load_dwordx4 v[76:79], v192, s[44:47], s42 offen sc1
    buffer_load_dwordx4 v[80:83], v192, s[44:47], s42 offen offset:64 sc1
    buffer_load_dwordx4 v[84:87], v192, s[44:47], s42 offen offset:128 sc1
    s_waitcnt vmcnt(3)
    v_xor_b32 v30, s29, v67
    v_bitop3_b32 v30, v71, s29, v30 bitop3:0xbe
    v_bitop3_b32 v30, v75, s29, v30 bitop3:0xbe
    v_mov_b32 v67, v72
    v_mov_b32 v71, v73
    ds_write_b128 v193, v[64:67]
    ds_write_b128 v193, v[68:71] offset:1024
    s_waitcnt vmcnt(0)
    v_bitop3_b32 v30, v79, s29, v30 bitop3:0xbe
    v_bitop3_b32 v30, v83, s29, v30 bitop3:0xbe
    v_bitop3_b32 v30, v87, s29, v30 bitop3:0xbe
    v_mov_b32 v79, v84
    v_mov_b32 v83, v85
    ds_write_b128 v193, v[76:79] offset:2048
    ds_write_b128 v193, v[80:83] offset:3072
    v_cmp_ne_u32 vcc, 0, v30
    s_cbranch_vccnz L_e1
L_e1ok:
    s_waitcnt lgkmcnt(0)
    s_barrier
    s_setprio 0
    s_cmp_lt_u32 s2, 216
    s_cselect_b32 s100, s96, 0
    s_cmp_eq_u32 s100, 2
    s_cbranch_scc0 L_now1_0
    s_mov_b32 s52, s18
    s_and_b32 s53, s19, 0xffff
    s_mov_b32 s54, 5308416
    s_mov_b32 s55, 0x00020000
    buffer_load_dwordx4 v[128:131], v11, s[52:55], s1 offen nt
    s_add_u32 s1, s1, 9216
    buffer_load_dwordx4 v[132:135], v11, s[52:55], s1 offen nt
    s_add_u32 s1, s1, 9216
    buffer_load_dwordx4 v[136:139], v11, s[52:55], s1 offen nt
    s_add_u32 s1, s1, 9216
    buffer_load_dwordx4 v[140:143], v11, s[52:55], s1 offen nt
    s_add_u32 s1, s1, 9216
    buffer_load_dwordx4 v[144:147], v11, s[52:55], s1 offen nt
    s_add_u32 s1, s1, 9216
    buffer_load_dwordx4 v[148:151], v11, s[52:55], s1 offen nt
    s_add_u32 s1, s1, 9216
    buffer_load_dwordx4 v[152:155], v11, s[52:55], s1 offen nt
    s_add_u32 s1, s1, 9216
    buffer_load_dwordx4 v[156:159], v11, s[52:55], s1 offen nt
    s_add_u32 s1, s1, 9216
    buffer_load_dwordx4 v[160:163], v11, s[52:55], s1 offen nt
    s_add_u32 s1, s1, 9216
    buffer_load_dwordx4 v[164:167], v11, s[52:55], s1 offen nt
    s_add_u32 s1, s1, 9216
    buffer_load_dwordx4 v[168:171], v11, s[52:55], s1 offen nt
    s_add_u32 s1, s1, 9216
    buffer_load_dwordx4 v[172:175], v11, s[52:55], s1 offen nt
    s_add_u32 s1, s1, 9216
    buffer_load_dwordx4 v[176:179], v11, s[52:55], s1 offen nt
    s_add_u32 s1, s1, 9216
    buffer_load_dwordx4 v[180:183], v11, s[52:55], s1 offen nt
    s_add_u32 s1, s1, 9216
    buffer_load_dwordx4 v[64:67], v11, s[52:55], s1 offen nt
    s_add_u32 s1, s1, 9216
    buffer_load_dwordx4 v[68:71], v11, s[52:55], s1 offen nt
    s_add_u32 s1, s1, 9216
    buffer_load_dwordx4 v[72:75], v11, s[52:55], s1 offen nt
    s_add_u32 s1, s1, 9216
    buffer_load_dwordx4 v[76:79], v11, s[52:55], s1 offen nt
    s_add_u32 s1, s1, 9216
    buffer_load_dwordx4 v[80:83], v11, s[52:55], s1 offen nt
    s_add_u32 s1, s1, 9216
    buffer_load_dwordx4 v[84:87], v11, s[52:55], s1 offen nt
    s_add_u32 s1, s1, 9216
    buffer_load_dwordx4 v[40:43], v11, s[52:55], s1 offen nt
    s_add_u32 s1, s1, 9216
    buffer_load_dwordx4 v[44:47], v11, s[52:55], s1 offen nt
    s_add_u32 s1, s1, 9216
    buffer_load_dwordx4 v[48:51], v11, s[52:55], s1 offen nt
    s_add_u32 s1, s1, 9216
    buffer_load_dwordx4 v[52:55], v11, s[52:55], s1 offen nt
    s_mov_b32 s52, s20
    s_and_b32 s53, s21, 0xffff
    s_mov_b32 s54, 5308416
    s_mov_b32 s55, 0x00020000
L_now1_0:
    s_mov_b32 s48, s14
    s_and_b32 s49, s15, 0xffff
    s_mov_b32 s50, 4718592
    s_mov_b32 s51, 0x00020000
    s_barrier
    s_barrier
    s_cmp_eq_u32 s100, 2
    s_cbranch_scc0 L_noF1
    s_lshl_b32 s42, s2, 10
    s_add_u32 s42, s42, 5505024
    v_and_b32 v56, v88, v3
    v_and_b32 v57, v88, v4
    v_and_b32 v58, v88, v5
    v_and_b32 v59, v88, v6
    v_and_b32 v60, v89, v3
    v_and_b32 v61, v89, v4
    v_and_b32 v62, v89, v5
    v_and_b32 v63, v89, v6
    s_waitcnt vmcnt(21)
    v_mfma_f32_16x16x32_bf16 v[20:23], v[56:59], v[128:131], 0
    v_and_b32 v56, v90, v3
    v_and_b32 v57, v90, v4
    v_and_b32 v58, v90, v5
    v_and_b32 v59, v90, v6
    v_mfma_f32_16x16x32_bf16 v[20:23], v[60:63], v[132:135], v[20:23]
    v_and_b32 v60, v91, v3
    v_and_b32 v61, v91, v4
    v_and_b32 v62, v91, v5
    v_and_b32 v63, v91, v6
    v_mfma_f32_16x16x32_bf16 v[20:23], v[56:59], v[136:139], v[20:23]
    v_and_b32 v56, v92, v3
    v_and_b32 v57, v92, v4
    v_and_b32 v58, v92, v5
    v_and_b32 v59, v92, v6
    s_waitcnt vmcnt(18)
    v_mfma_f32_16x16x32_bf16 v[20:23], v[60:63], v[140:143], v[20:23]
    v_and_b32 v60, v93, v3
    v_and_b32 v61, v93, v4
    v_and_b32 v62, v93, v5
    v_and_b32 v63, v93, v6
    v_mfma_f32_16x16x32_bf16 v[20:23], v[56:59], v[144:147], v[20:23]
    v_and_b32 v56, v94, v3
    v_and_b32 v57, v94, v4
    v_and_b32 v58, v94, v5
    v_and_b32 v59, v94, v6
    v_mfma_f32_16x16x32_bf16 v[20:23], v[60:63], v[148:151], v[20:23]
    v_and_b32 v60, v95, v3
    v_and_b32 v61, v95, v4
    v_and_b32 v62, v95, v5
    v_and_b32 v63, v95, v6
    s_waitcnt vmcnt(15)
    v_mfma_f32_16x16x32_bf16 v[20:23], v[56:59], v[152:155], v[20:23]
    v_and_b32 v56, v112, v3
    v_and_b32 v57, v112, v4
    v_and_b32 v58, v112, v5
    v_and_b32 v59, v112, v6
    v_mfma_f32_16x16x32_bf16 v[20:23], v[60:63], v[156:159], v[20:23]
    v_and_b32 v60, v113, v3
    v_and_b32 v61, v113, v4
    v_and_b32 v62, v113, v5
    v_and_b32 v63, v113, v6
    v_mfma_f32_16x16x32_bf16 v[20:23], v[56:59], v[160:163], v[20:23]
    v_and_b32 v56, v114, v3
    v_and_b32 v57, v114, v4
    v_and_b32 v58, v114, v5
    v_and_b32 v59, v114, v6
    s_waitcnt vmcnt(12)
    v_mfma_f32_16x16x32_bf16 v[20:23], v[60:63], v[164:167], v[20:23]
    v_and_b32 v60, v115, v3
    v_and_b32 v61, v115, v4
    v_and_b32 v62, v115, v5
    v_and_b32 v63, v115, v6
    v_mfma_f32_16x16x32_bf16 v[20:23], v[56:59], v[168:171], v[20:23]
    v_and_b32 v56, v116, v3
    v_and_b32 v57, v116, v4
    v_and_b32 v58, v116, v5
    v_and_b32 v59, v116, v6
    v_mfma_f32_16x16x32_bf16 v[20:23], v[60:63], v[172:175], v[20:23]
    v_and_b32 v60, v117, v3
    v_and_b32 v61, v117, v4
    v_and_b32 v62, v117, v5
    v_and_b32 v63, v117, v6
    s_waitcnt vmcnt(9)
    v_mfma_f32_16x16x32_bf16 v[20:23], v[56:59], v[176:179], v[20:23]
    v_and_b32 v56, v118, v3
    v_and_b32 v57, v118, v4
    v_and_b32 v58, v118, v5
    v_and_b32 v59, v118, v6
    v_mfma_f32_16x16x32_bf16 v[20:23], v[60:63], v[180:183], v[20:23]
    v_and_b32 v60, v119, v3
    v_and_b32 v61, v119, v4
    v_and_b32 v62, v119, v5
    v_and_b32 v63, v119, v6
    v_mfma_f32_16x16x32_bf16 v[20:23], v[56:59], v[64:67], v[20:23]
    v_and_b32 v56, v120, v3
    v_and_b32 v57, v120, v4
    v_and_b32 v58, v120, v5
    v_and_b32 v59, v120, v6
    s_waitcnt vmcnt(6)
    v_mfma_f32_16x16x32_bf16 v[20:23], v[60:63], v[68:71], v[20:23]
    v_and_b32 v60, v121, v3
    v_and_b32 v61, v121, v4
    v_and_b32 v62, v121, v5
    v_and_b32 v63, v121, v6
    v_mfma_f32_16x16x32_bf16 v[20:23], v[56:59], v[72:75], v[20:23]
    v_and_b32 v56, v122, v3
    v_and_b32 v57, v122, v4
    v_and_b32 v58, v122, v5
    v_and_b32 v59, v122, v6
    v_mfma_f32_16x16x32_bf16 v[20:23], v[60:63], v[76:79], v[20:23]
    v_and_b32 v60, v123, v3
    v_and_b32 v61, v123, v4
    v_and_b32 v62, v123, v5
    v_and_b32 v63, v123, v6
    s_waitcnt vmcnt(3)
    v_mfma_f32_16x16x32_bf16 v[20:23], v[56:59], v[80:83], v[20:23]
    v_and_b32 v56, v124, v3
    v_and_b32 v57, v124, v4
    v_and_b32 v58, v124, v5
    v_and_b32 v59, v124, v6
    v_mfma_f32_16x16x32_bf16 v[20:23], v[60:63], v[84:87], v[20:23]
    v_and_b32 v60, v125, v3
    v_and_b32 v61, v125, v4
    v_and_b32 v62, v125, v5
    v_and_b32 v63, v125, v6
    v_mfma_f32_16x16x32_bf16 v[20:23], v[56:59], v[40:43], v[20:23]
    v_and_b32 v56, v126, v3
    v_and_b32 v57, v126, v4
    v_and_b32 v58, v126, v5
    v_and_b32 v59, v126, v6
    s_waitcnt vmcnt(0)
    v_mfma_f32_16x16x32_bf16 v[20:23], v[60:63], v[44:47], v[20:23]
    v_and_b32 v60, v127, v3
    v_and_b32 v61, v127, v4
    v_and_b32 v62, v127, v5
    v_and_b32 v63, v127, v6
    v_mfma_f32_16x16x32_bf16 v[20:23], v[56:59], v[48:51], v[20:23]
    s_nop 0
    v_mfma_f32_16x16x32_bf16 v[20:23], v[60:63], v[52:55], v[20:23]
    s_nop 7
    v_perm_b32 v20, v20, v7, s34
    v_perm_b32 v21, v21, v7, s35
    v_perm_b32 v22, v22, v7, s36
    v_perm_b32 v23, v23, v7, s37
    buffer_store_dwordx4 v[20:23], v8, s[44:47], s42 offen sc1
    s_branch L_uvok
L_noF1:
L_uvok:
    s_mov_b32 s16, -1
    s_mov_b32 s17, 0
L_gR:
    s_sub_u32 s33, s33, 1
    s_cbranch_scc1 L_timeout
    ds_read_b128 v[32:35], v194 offset:96
    s_waitcnt lgkmcnt(0)
    v_and_b32 v32, v32, v33
    v_bitop3_b32 v32, v32, v34, v35 bitop3:0x80
    v_cmp_eq_u32 vcc, 0, v32
    s_cbranch_vccnz L_gR
    s_mov_b32 s48, s12
    s_and_b32 s49, s13, 0xffff
    s_mov_b32 s50, 4194304
    s_mov_b32 s51, 0x00020000
    s_mov_b32 s97, 524288
    s_mov_b32 s98, 32768
    s_mov_b32 s99, 557056
    buffer_load_dwordx4 v[96:99], v197, s[48:51], 0 offen nt
    buffer_load_dwordx4 v[100:103], v197, s[48:51], s97 offen nt
    buffer_load_dwordx4 v[104:107], v197, s[48:51], s98 offen nt
    buffer_load_dwordx4 v[108:111], v197, s[48:51], s99 offen nt
    s_cmp_lt_u32 s2, 64
    s_cbranch_scc0 L_cl0
    s_cmp_eq_u32 s96, 3
    s_cbranch_scc0 L_now2y
    buffer_load_dwordx4 v[148:151], v202, s[52:55], 0 offen nt
    buffer_load_dwordx4 v[152:155], v202, s[52:55], 0 offen offset:1152 nt
    buffer_load_dwordx4 v[156:159], v202, s[52:55], 0 offen offset:2304 nt
    buffer_load_dwordx4 v[160:163], v202, s[52:55], 0 offen offset:3456 nt
    buffer_load_dwordx4 v[164:167], v203, s[52:55], 0 offen nt
L_now2y:
    buffer_load_dwordx4 v[128:131], v200, s[52:55], 0 offen nt
    buffer_load_dwordx4 v[132:135], v200, s[52:55], 0 offen offset:1152 nt
    buffer_load_dwordx4 v[136:139], v200, s[52:55], 0 offen offset:2304 nt
    buffer_load_dwordx4 v[140:143], v200, s[52:55], 0 offen offset:3456 nt
    buffer_load_dwordx4 v[144:147], v201, s[52:55], 0 offen nt
L_cl0:
    s_mov_b32 s48, s14
    s_and_b32 s49, s15, 0xffff
    s_mov_b32 s50, 4718592
    s_mov_b32 s51, 0x00020000
L_gF:
    s_sub_u32 s33, s33, 1
    s_cbranch_scc1 L_timeout
    ds_read_b128 v[32:35], v194 offset:16
    s_waitcnt lgkmcnt(0)
    v_and_b32 v32, v32, v33
    v_bitop3_b32 v32, v32, v34, v35 bitop3:0x80
    v_cmp_eq_u32 vcc, 0, v32
    s_cbranch_vccnz L_gF
    v_mov_b32 v34, v7
    s_mov_b32 exec_lo, 0x0f0f0f0f
    s_mov_b32 exec_hi, 0x0f0f0f0f
    buffer_load_dwordx3 v[32:34], v210, s[44:47], 0 offen sc1
    s_mov_b64 exec, -1
    buffer_load_dwordx4 v[168:171], v212, s[44:47], 0 offen sc1
    buffer_load_dwordx4 v[172:175], v212, s[44:47], 0 offen offset:512 sc1
    buffer_load_dwordx4 v[176:179], v212, s[44:47], 0 offen offset:1024 sc1
    buffer_load_dwordx4 v[180:183], v212, s[44:47], 0 offen offset:1536 sc1
    s_cmp_lt_u32 s2, 64
    s_cbranch_scc0 L_clw5
    s_cmp_eq_u32 s96, 3
    s_cbranch_scc1 L_clw15
    s_waitcnt vmcnt(10)
    s_branch L_clwx
L_clw15:
    s_waitcnt vmcnt(15)
    s_branch L_clwx
L_clw5:
    s_waitcnt vmcnt(5)
L_clwx:
    v_mfma_f32_16x16x32_bf16 v[40:43], v[96:99], v[228:231], 0
    v_mfma_f32_16x16x32_bf16 v[44:47], v[96:99], v[232:235], 0
    v_mfma_f32_16x16x32_bf16 v[48:51], v[100:103], v[228:231], 0
    v_mfma_f32_16x16x32_bf16 v[52:55], v[100:103], v[232:235], 0
    s_nop 4
    v_cvt_pk_bf16_f32 v112, v40, v41
    v_cvt_pk_bf16_f32 v113, v42, v43
    v_cvt_pk_bf16_f32 v114, v48, v49
    v_cvt_pk_bf16_f32 v115, v50, v51
    v_cvt_pk_bf16_f32 v116, v44, v45
    v_cvt_pk_bf16_f32 v117, v46, v47
    v_cvt_pk_bf16_f32 v118, v52, v53
    v_cvt_pk_bf16_f32 v119, v54, v55
    v_mfma_f32_16x16x32_bf16 v[40:43], v[104:107], v[228:231], 0
    v_mfma_f32_16x16x32_bf16 v[44:47], v[104:107], v[232:235], 0
    v_mfma_f32_16x16x32_bf16 v[48:51], v[108:111], v[228:231], 0
    v_mfma_f32_16x16x32_bf16 v[52:55], v[108:111], v[232:235], 0
    s_nop 4
    v_cvt_pk_bf16_f32 v120, v40, v41
    v_cvt_pk_bf16_f32 v121, v42, v43
    v_cvt_pk_bf16_f32 v122, v48, v49
    v_cvt_pk_bf16_f32 v123, v50, v51
    v_cvt_pk_bf16_f32 v124, v44, v45
    v_cvt_pk_bf16_f32 v125, v46, v47
    v_cvt_pk_bf16_f32 v126, v52, v53
    v_cvt_pk_bf16_f32 v127, v54, v55
L_e2:
    s_waitcnt vmcnt(4)
    v_cmp_ne_u32 vcc, s29, v34
    s_cbranch_vccz L_okF
    s_sub_u32 s33, s33, 64
    s_cbranch_scc1 L_timeout
    s_mov_b32 exec_lo, 0x0f0f0f0f
    s_mov_b32 exec_hi, 0x0f0f0f0f
    buffer_load_dwordx3 v[32:34], v210, s[44:47], 0 offen sc1
    s_mov_b64 exec, -1
    buffer_load_dwordx4 v[168:171], v212, s[44:47], 0 offen sc1
    buffer_load_dwordx4 v[172:175], v212, s[44:47], 0 offen offset:512 sc1
    buffer_load_dwordx4 v[176:179], v212, s[44:47], 0 offen offset:1024 sc1
    buffer_load_dwordx4 v[180:183], v212, s[44:47], 0 offen offset:1536 sc1
    s_branch L_e2
L_okF:
    ds_write_b32 v194, v196 offset:80
    buffer_load_dwordx4 v[64:67], v198, s[48:51], 0 offen nt
    buffer_load_dwordx4 v[68:71], v198, s[48:51], 0 offen offset:1152 nt
    buffer_load_dwordx4 v[72:75], v198, s[48:51], 0 offen offset:2304 nt
    buffer_load_dwordx4 v[76:79], v198, s[48:51], 0 offen offset:3456 nt
    v_max_f32_dpp v12, v32, v32 quad_perm:[1,0,3,2] row_mask:0xf bank_mask:0xf
    s_nop 1
    v_max_f32_dpp v12, v12, v12 quad_perm:[2,3,0,1] row_mask:0xf bank_mask:0xf
    v_mov_b32 v30, v12
    s_nop 1
    v_permlane16_swap_b32 v12, v30
    v_max_f32 v12, v12, v30
    v_mov_b32 v30, v12
    s_nop 1
    v_permlane32_swap_b32 v12, v30
    v_max_f32 v12, v12, v30
    v_sub_f32 v13, v32, v12
    v_exp_f32 v13, v13
    s_nop 0
    v_cvt_pk_bf16_f32 v13, v13, v13
    s_nop 1
    v_mov_b32_dpp v16, v13 row_newbcast:0 row_mask:0xf bank_mask:0x3
    v_mov_b32_dpp v17, v13 row_newbcast:1 row_mask:0xf bank_mask:0x3
    v_mov_b32_dpp v18, v13 row_newbcast:2 row_mask:0xf bank_mask:0x3
    v_mov_b32_dpp v19, v13 row_newbcast:3 row_mask:0xf bank_mask:0x3
    v_mov_b32_dpp v16, v13 row_newbcast:8 row_mask:0xf bank_mask:0xc
    v_mov_b32_dpp v17, v13 row_newbcast:9 row_mask:0xf bank_mask:0xc
    v_mov_b32_dpp v18, v13 row_newbcast:10 row_mask:0xf bank_mask:0xc
    v_mov_b32_dpp v19, v13 row_newbcast:11 row_mask:0xf bank_mask:0xc
    v_and_b32 v13, 0xffff0000, v13
    v_mul_f32 v13, v13, v33
    v_and_b32 v40, v16, v3
    v_and_b32 v41, v16, v4
    v_and_b32 v42, v16, v5
    v_and_b32 v43, v16, v6
    v_and_b32 v44, v17, v3
    v_and_b32 v45, v17, v4
    v_and_b32 v46, v17, v5
    v_and_b32 v47, v17, v6
    v_and_b32 v48, v18, v3
    v_and_b32 v49, v18, v4
    v_and_b32 v50, v18, v5
    v_and_b32 v51, v18, v6
    v_and_b32 v52, v19, v3
    v_and_b32 v53, v19, v4
    v_and_b32 v54, v19, v5
    v_and_b32 v55, v19, v6
    v_add_f32_dpp v13, v13, v13 quad_perm:[1,0,3,2] row_mask:0xf bank_mask:0xf
    s_nop 1
    v_add_f32_dpp v13, v13, v13 quad_perm:[2,3,0,1] row_mask:0xf bank_mask:0xf
    v_mov_b32 v30, v13
    s_nop 1
    v_permlane16_swap_b32 v13, v30
    v_add_f32 v13, v13, v30
    v_mov_b32 v30, v13
    s_nop 1
    v_permlane32_swap_b32 v13, v30
    v_add_f32 v13, v13, v30
    s_mov_b64 exec, 0x101
    ds_write_b64 v252, v[12:13]
    s_mov_b64 exec, -1
    s_mov_b32 s100, 0x00010001
    s_waitcnt vmcnt(7)
    v_xor_b32 v31, v168, v236
    v_bitop3_b32 v31, v169, v237, v31 bitop3:0xbe
    v_bitop3_b32 v31, v170, v238, v31 bitop3:0xbe
    v_bitop3_b32 v31, v171, v239, v31 bitop3:0xbe
    v_mfma_f32_16x16x32_bf16 v[32:35], v[40:43], v[168:171], 0
    s_waitcnt vmcnt(6)
    v_bitop3_b32 v31, v172, v240, v31 bitop3:0xbe
    v_bitop3_b32 v31, v173, v241, v31 bitop3:0xbe
    v_bitop3_b32 v31, v174, v242, v31 bitop3:0xbe
    v_bitop3_b32 v31, v175, v243, v31 bitop3:0xbe
    v_mfma_f32_16x16x32_bf16 v[32:35], v[44:47], v[172:175], v[32:35]
    s_waitcnt vmcnt(5)
    v_bitop3_b32 v31, v176, v244, v31 bitop3:0xbe
    v_bitop3_b32 v31, v177, v245, v31 bitop3:0xbe
    v_bitop3_b32 v31, v178, v246, v31 bitop3:0xbe
    v_bitop3_b32 v31, v179, v247, v31 bitop3:0xbe
    v_mfma_f32_16x16x32_bf16 v[32:35], v[48:51], v[176:179], v[32:35]
    s_waitcnt vmcnt(4)
    v_bitop3_b32 v31, v180, v248, v31 bitop3:0xbe
    v_bitop3_b32 v31, v181, v249, v31 bitop3:0xbe
    v_bitop3_b32 v31, v182, v250, v31 bitop3:0xbe
    v_bitop3_b32 v31, v183, v251, v31 bitop3:0xbe
    v_mfma_f32_16x16x32_bf16 v[32:35], v[52:55], v[180:183], v[32:35]
    v_and_b32 v31, s100, v31
    v_cmp_ne_u32 vcc, 0, v31
    s_cbranch_vccz L_okR
L_rr:
    s_sub_u32 s33, s33, 64
    s_cbranch_scc1 L_timeout
    buffer_load_dwordx4 v[168:171], v212, s[44:47], 0 offen sc1
    buffer_load_dwordx4 v[172:175], v212, s[44:47], 0 offen offset:512 sc1
    buffer_load_dwordx4 v[176:179], v212, s[44:47], 0 offen offset:1024 sc1
    buffer_load_dwordx4 v[180:183], v212, s[44:47], 0 offen offset:1536 sc1
    s_waitcnt vmcnt(0)
    v_xor_b32 v31, v168, v236
    v_bitop3_b32 v31, v169, v237, v31 bitop3:0xbe
    v_bitop3_b32 v31, v170, v238, v31 bitop3:0xbe
    v_bitop3_b32 v31, v171, v239, v31 bitop3:0xbe
    v_bitop3_b32 v31, v172, v240, v31 bitop3:0xbe
    v_bitop3_b32 v31, v173, v241, v31 bitop3:0xbe
    v_bitop3_b32 v31, v174, v242, v31 bitop3:0xbe
    v_bitop3_b32 v31, v175, v243, v31 bitop3:0xbe
    v_bitop3_b32 v31, v176, v244, v31 bitop3:0xbe
    v_bitop3_b32 v31, v177, v245, v31 bitop3:0xbe
    v_bitop3_b32 v31, v178, v246, v31 bitop3:0xbe
    v_bitop3_b32 v31, v179, v247, v31 bitop3:0xbe
    v_bitop3_b32 v31, v180, v248, v31 bitop3:0xbe
    v_bitop3_b32 v31, v181, v249, v31 bitop3:0xbe
    v_bitop3_b32 v31, v182, v250, v31 bitop3:0xbe
    v_bitop3_b32 v31, v183, v251, v31 bitop3:0xbe
    v_and_b32 v31, s100, v31
    v_cmp_ne_u32 vcc, 0, v31
    s_cbranch_vccnz L_rr
    v_mfma_f32_16x16x32_bf16 v[32:35], v[40:43], v[168:171], 0
    v_mfma_f32_16x16x32_bf16 v[32:35], v[44:47], v[172:175], v[32:35]
    v_mfma_f32_16x16x32_bf16 v[32:35], v[48:51], v[176:179], v[32:35]
    v_mfma_f32_16x16x32_bf16 v[32:35], v[52:55], v[180:183], v[32:35]
L_okR:
    s_nop 7
    v_cvt_pk_bf16_f32 v36, v32, v33
    v_cvt_pk_bf16_f32 v37, v34, v35
    ds_write_b64 v213, v[36:37]
    ds_write_b32 v195, v196 offset:32
    s_cmp_eq_u32 s96, 3
    s_cbranch_scc0 L_nowox
    buffer_load_dwordx4 v[80:83], v199, s[48:51], 0 offen nt
    buffer_load_dwordx4 v[84:87], v199, s[48:51], 0 offen offset:1152 nt
    buffer_load_dwordx4 v[88:91], v199, s[48:51], 0 offen offset:2304 nt
    buffer_load_dwordx4 v[92:95], v199, s[48:51], 0 offen offset:3456 nt
L_nowox:
    s_cmp_lt_u32 s2, 64
    s_cbranch_scc1 L_cl5
    s_cmp_eq_u32 s96, 3
    s_cbranch_scc0 L_now2x
    buffer_load_dwordx4 v[148:151], v202, s[52:55], 0 offen nt
    buffer_load_dwordx4 v[152:155], v202, s[52:55], 0 offen offset:1152 nt
    buffer_load_dwordx4 v[156:159], v202, s[52:55], 0 offen offset:2304 nt
    buffer_load_dwordx4 v[160:163], v202, s[52:55], 0 offen offset:3456 nt
    buffer_load_dwordx4 v[164:167], v203, s[52:55], 0 offen nt
L_now2x:
    buffer_load_dwordx4 v[128:131], v200, s[52:55], 0 offen nt
    buffer_load_dwordx4 v[132:135], v200, s[52:55], 0 offen offset:1152 nt
    buffer_load_dwordx4 v[136:139], v200, s[52:55], 0 offen offset:2304 nt
    buffer_load_dwordx4 v[140:143], v200, s[52:55], 0 offen offset:3456 nt
    buffer_load_dwordx4 v[144:147], v201, s[52:55], 0 offen nt
L_cl5:
    s_cmp_lt_u32 s2, 72
    s_cbranch_scc0 L_noxr
    buffer_load_ushort v224, v223, s[56:59], 0 offen
L_noxr:
L_gx:
    s_sub_u32 s33, s33, 1
    s_cbranch_scc1 L_timeout
    ds_read_b128 v[32:35], v194 offset:32
    ds_read_b64 v[12:13], v253
    ds_read_b128 v[40:43], v214
    ds_read_b128 v[44:47], v214 offset:64
    s_waitcnt lgkmcnt(3)
    v_and_b32 v32, v32, v33
    v_bitop3_b32 v32, v32, v34, v35 bitop3:0x80
    v_cmp_eq_u32 vcc, 0, v32
    s_cbranch_vccnz L_gx
    s_mov_b32 s97, 3145728
    s_movk_i32 s98, 16
    s_waitcnt lgkmcnt(1)
    v_mfma_f32_16x16x32_bf16 v[48:51], v[112:115], v[40:43], 0
    v_mfma_f32_16x16x32_bf16 v[52:55], v[116:119], v[40:43], 0
    v_max_f32_dpp v14, v12, v12 quad_perm:[1,0,3,2] row_mask:0xf bank_mask:0xf
    s_waitcnt lgkmcnt(0)
    v_mfma_f32_16x16x32_bf16 v[48:51], v[120:123], v[44:47], v[48:51]
    v_mfma_f32_16x16x32_bf16 v[52:55], v[124:127], v[44:47], v[52:55]
    v_max_f32_dpp v14, v14, v14 quad_perm:[2,3,0,1] row_mask:0xf bank_mask:0xf
    v_sub_f32 v12, v12, v14
    v_exp_f32 v12, v12
    s_nop 0
    v_mul_f32 v13, v13, v12
    s_nop 1
    v_add_f32_dpp v13, v13, v13 quad_perm:[1,0,3,2] row_mask:0xf bank_mask:0xf
    s_nop 1
    v_add_f32_dpp v13, v13, v13 quad_perm:[2,3,0,1] row_mask:0xf bank_mask:0xf
    v_rcp_f32 v13, v13
    s_nop 0
    v_mul_f32 v12, v12, v13
    s_mov_b32 s16, 0x11111111
    s_mov_b32 s17, 0x11111111
    s_mov_b32 vcc_lo, 0x00ff00ff
    s_mov_b32 vcc_hi, 0x00ff00ff
    v_cndmask_b32 v48, v52, v48, vcc
    v_cndmask_b32 v49, v53, v49, vcc
    v_cndmask_b32 v50, v54, v50, vcc
    v_cndmask_b32 v51, v55, v51, vcc
    v_mul_f32 v48, v48, v12
    v_mul_f32 v49, v49, v12
    v_mul_f32 v50, v50, v12
    v_mul_f32 v51, v51, v12
    v_add_f32_dpp v48, v48, v48 quad_perm:[1,0,3,2] row_mask:0xf bank_mask:0xf
    v_add_f32_dpp v49, v49, v49 quad_perm:[1,0,3,2] row_mask:0xf bank_mask:0xf
    v_add_f32_dpp v50, v50, v50 quad_perm:[1,0,3,2] row_mask:0xf bank_mask:0xf
    v_add_f32_dpp v51, v51, v51 quad_perm:[1,0,3,2] row_mask:0xf bank_mask:0xf
    v_add_f32_dpp v48, v48, v48 quad_perm:[2,3,0,1] row_mask:0xf bank_mask:0xf
    v_add_f32_dpp v49, v49, v49 quad_perm:[2,3,0,1] row_mask:0xf bank_mask:0xf
    v_add_f32_dpp v50, v50, v50 quad_perm:[2,3,0,1] row_mask:0xf bank_mask:0xf
    v_add_f32_dpp v51, v51, v51 quad_perm:[2,3,0,1] row_mask:0xf bank_mask:0xf
    v_perm_b32 v36, v48, v7, s34
    v_perm_b32 v37, v49, v7, s35
    v_perm_b32 v38, v50, v7, s36
    v_perm_b32 v39, v51, v7, s37
    s_mov_b64 exec, s[16:17]
    buffer_store_dwordx4 v[36:39], v215, s[44:47], s97 offen
    s_mov_b64 exec, -1
    buffer_load_dwordx4 v[32:35], v216, s[44:47], s97 offen sc1
L_gha:
    s_sub_u32 s33, s33, 1
    s_cbranch_scc1 L_timeout
    ds_read_b32 v30, v194 offset:12
    ds_read_b128 v[12:15], v208
    ds_read_b32 v16, v209
    s_waitcnt lgkmcnt(0)
    v_cmp_eq_u32 vcc, 0, v30
    s_cbranch_vccnz L_gha
    v_and_b32 v40, v12, v3
    v_and_b32 v41, v12, v4
    v_and_b32 v42, v12, v5
    v_and_b32 v43, v12, v6
    v_and_b32 v44, v13, v3
    v_and_b32 v45, v13, v4
    v_and_b32 v46, v13, v5
    v_and_b32 v47, v13, v6
    v_and_b32 v48, v14, v3
    v_and_b32 v49, v14, v4
    v_and_b32 v50, v14, v5
    v_and_b32 v51, v14, v6
    v_and_b32 v52, v15, v3
    v_and_b32 v53, v15, v4
    v_and_b32 v54, v15, v5
    v_and_b32 v55, v15, v6
    v_and_b32 v56, v16, v3
    v_and_b32 v57, v16, v4
    v_and_b32 v58, v16, v5
    v_and_b32 v59, v16, v6
    s_waitcnt vmcnt(2)
    v_mfma_f32_16x16x32_bf16 v[20:23], v[40:43], v[128:131], 0
    v_mfma_f32_16x16x32_bf16 v[24:27], v[40:43], v[148:151], 0
    v_mfma_f32_16x16x32_bf16 v[20:23], v[44:47], v[132:135], v[20:23]
    v_mfma_f32_16x16x32_bf16 v[24:27], v[44:47], v[152:155], v[24:27]
    v_mfma_f32_16x16x32_bf16 v[20:23], v[48:51], v[136:139], v[20:23]
    v_mfma_f32_16x16x32_bf16 v[24:27], v[48:51], v[156:159], v[24:27]
    v_mfma_f32_16x16x32_bf16 v[20:23], v[52:55], v[140:143], v[20:23]
    v_mfma_f32_16x16x32_bf16 v[24:27], v[52:55], v[160:163], v[24:27]
    v_mfma_f32_16x16x32_bf16 v[20:23], v[56:59], v[144:147], v[20:23]
    v_mfma_f32_16x16x32_bf16 v[24:27], v[56:59], v[164:167], v[24:27]
    s_branch L_e2c
L_e2b:
    s_sub_u32 s33, s33, 64
    s_cbranch_scc1 L_timeout
    s_sub_u32 s98, s98, 1
    s_cbranch_scc0 L_e2d
    s_mov_b32 s97, 0
    s_mov_b64 exec, s[16:17]
    buffer_store_dwordx4 v[36:39], v215, s[44:47], 0 offen sc1
    s_mov_b64 exec, -1
L_e2d:
    buffer_load_dwordx4 v[32:35], v216, s[44:47], s97 offen sc1
L_e2c:
    s_waitcnt vmcnt(0)
    v_xor_b32 v30, s29, v32
    v_bitop3_b32 v30, v33, s30, v30 bitop3:0xbe
    v_bitop3_b32 v30, v34, s31, v30 bitop3:0xbe
    v_bitop3_b32 v30, v35, s32, v30 bitop3:0xbe
    v_and_b32 v30, 0xff, v30
    v_cmp_ne_u32 vcc, 0, v30
    s_cbranch_vccnz L_e2b
    s_cmp_eq_u32 s97, 0
    s_cbranch_scc1 L_e2e
    s_mov_b64 exec, s[16:17]
    buffer_store_dwordx4 v[36:39], v215, s[44:47], 0 offen sc1
    s_mov_b64 exec, -1
L_e2e:
    v_add_f32_dpp v32, v32, v32 quad_perm:[1,0,3,2] row_mask:0xf bank_mask:0xf
    v_add_f32_dpp v33, v33, v33 quad_perm:[1,0,3,2] row_mask:0xf bank_mask:0xf
    v_add_f32_dpp v34, v34, v34 quad_perm:[1,0,3,2] row_mask:0xf bank_mask:0xf
    v_add_f32_dpp v35, v35, v35 quad_perm:[1,0,3,2] row_mask:0xf bank_mask:0xf
    v_add_f32_dpp v32, v32, v32 quad_perm:[2,3,0,1] row_mask:0xf bank_mask:0xf
    v_add_f32_dpp v33, v33, v33 quad_perm:[2,3,0,1] row_mask:0xf bank_mask:0xf
    v_add_f32_dpp v34, v34, v34 quad_perm:[2,3,0,1] row_mask:0xf bank_mask:0xf
    v_add_f32_dpp v35, v35, v35 quad_perm:[2,3,0,1] row_mask:0xf bank_mask:0xf
    v_add_f32_dpp v32, v32, v32 row_half_mirror row_mask:0xf bank_mask:0xf
    v_add_f32_dpp v33, v33, v33 row_half_mirror row_mask:0xf bank_mask:0xf
    v_add_f32_dpp v34, v34, v34 row_half_mirror row_mask:0xf bank_mask:0xf
    v_add_f32_dpp v35, v35, v35 row_half_mirror row_mask:0xf bank_mask:0xf
    v_cvt_pk_bf16_f32 v32, v32, v32
    v_cvt_pk_bf16_f32 v33, v33, v33
    v_cvt_pk_bf16_f32 v34, v34, v34
    v_cvt_pk_bf16_f32 v35, v35, v35
    v_and_b32 v40, v32, v3
    v_and_b32 v41, v32, v4
    v_and_b32 v42, v32, v5
    v_and_b32 v43, v32, v6
    v_and_b32 v44, v33, v3
    v_and_b32 v45, v33, v4
    v_and_b32 v46, v33, v5
    v_and_b32 v47, v33, v6
    v_and_b32 v48, v34, v3
    v_and_b32 v49, v34, v4
    v_and_b32 v50, v34, v5
    v_and_b32 v51, v34, v6
    v_and_b32 v52, v35, v3
    v_and_b32 v53, v35, v4
    v_and_b32 v54, v35, v5
    v_and_b32 v55, v35, v6
    v_mfma_f32_16x16x32_bf16 v[20:23], v[40:43], v[64:67], v[20:23]
    v_mfma_f32_16x16x32_bf16 v[24:27], v[40:43], v[80:83], v[24:27]
    v_mfma_f32_16x16x32_bf16 v[20:23], v[44:47], v[68:71], v[20:23]
    v_mfma_f32_16x16x32_bf16 v[24:27], v[44:47], v[84:87], v[24:27]
    v_mfma_f32_16x16x32_bf16 v[20:23], v[48:51], v[72:75], v[20:23]
    v_mfma_f32_16x16x32_bf16 v[24:27], v[48:51], v[88:91], v[24:27]
    v_mfma_f32_16x16x32_bf16 v[20:23], v[52:55], v[76:79], v[20:23]
    v_mfma_f32_16x16x32_bf16 v[24:27], v[52:55], v[92:95], v[24:27]
    s_nop 6
    v_perm_b32 v20, v20, v7, s34
    v_perm_b32 v21, v21, v7, s35
    v_perm_b32 v22, v22, v7, s36
    v_perm_b32 v23, v23, v7, s37
    buffer_store_dwordx4 v[20:23], v218, s[44:47], 0 offen sc1
    v_perm_b32 v24, v24, v7, s34
    v_perm_b32 v25, v25, v7, s35
    v_perm_b32 v26, v26, v7, s36
    v_perm_b32 v27, v27, v7, s37
    buffer_store_dwordx4 v[24:27], v219, s[44:47], 0 offen sc1
    s_cmp_lt_u32 s2, 72
    s_cbranch_scc0 L_done
    s_mov_b32 s43, 73728
    s_mov_b32 s97, 147456
    s_mov_b32 s98, 221184
    s_waitcnt vmcnt(0)
L_e3:
    s_sub_u32 s33, s33, 64
    s_cbranch_scc1 L_timeout
    buffer_load_dwordx4 v[64:67], v220, s[44:47], 0 offen sc1
    buffer_load_dwordx4 v[68:71], v220, s[44:47], s43 offen sc1
    buffer_load_dwordx4 v[72:75], v220, s[44:47], s97 offen sc1
    buffer_load_dwordx4 v[76:79], v220, s[44:47], s98 offen sc1
    s_waitcnt vmcnt(3)
    v_xor_b32 v30, s29, v64
    v_bitop3_b32 v30, v65, s30, v30 bitop3:0xbe
    v_bitop3_b32 v30, v66, s31, v30 bitop3:0xbe
    v_bitop3_b32 v30, v67, s32, v30 bitop3:0xbe
    s_waitcnt vmcnt(2)
    v_bitop3_b32 v30, v68, s29, v30 bitop3:0xbe
    v_bitop3_b32 v30, v69, s30, v30 bitop3:0xbe
    v_bitop3_b32 v30, v70, s31, v30 bitop3:0xbe
    v_bitop3_b32 v30, v71, s32, v30 bitop3:0xbe
    v_pk_add_f32 v[64:65], v[64:65], v[68:69]
    v_pk_add_f32 v[66:67], v[66:67], v[70:71]
    s_waitcnt vmcnt(1)
    v_bitop3_b32 v30, v72, s29, v30 bitop3:0xbe
    v_bitop3_b32 v30, v73, s30, v30 bitop3:0xbe
    v_bitop3_b32 v30, v74, s31, v30 bitop3:0xbe
    v_bitop3_b32 v30, v75, s32, v30 bitop3:0xbe
    v_pk_add_f32 v[64:65], v[64:65], v[72:73]
    v_pk_add_f32 v[66:67], v[66:67], v[74:75]
    s_waitcnt vmcnt(0)
    v_bitop3_b32 v30, v76, s29, v30 bitop3:0xbe
    v_bitop3_b32 v30, v77, s30, v30 bitop3:0xbe
    v_bitop3_b32 v30, v78, s31, v30 bitop3:0xbe
    v_bitop3_b32 v30, v79, s32, v30 bitop3:0xbe
    v_pk_add_f32 v[64:65], v[64:65], v[76:77]
    v_pk_add_f32 v[66:67], v[66:67], v[78:79]
    v_and_b32 v30, 0xff, v30
    v_cmp_ne_u32 vcc, 0, v30
    s_cbranch_vccnz L_e3
    v_permlane16_swap_b32 v64, v65
    v_permlane16_swap_b32 v66, v67
    v_add_f32 v64, v64, v65
    v_add_f32 v66, v66, v67
    s_nop 1
    v_permlane32_swap_b32 v64, v66
    v_add_f32 v64, v64, v66
    s_nop 1
    v_add_f32_dpp v64, v64, v64 row_ror:4 row_mask:0xf bank_mask:0xf
    s_nop 1
    v_add_f32_dpp v64, v64, v64 row_ror:8 row_mask:0xf bank_mask:0xf
    ds_write_b32 v221, v64
    ds_write_b32 v195, v196 offset:48
    s_cmp_eq_u32 s96, 0
    s_cbranch_scc0 L_done
L_gz:
    s_sub_u32 s33, s33, 1
    s_cbranch_scc1 L_timeout
    ds_read_b128 v[32:35], v194 offset:48
    ds_read_b32 v36, v222 offset:0
    ds_read_b32 v37, v222 offset:64
    ds_read_b32 v38, v222 offset:128
    ds_read_b32 v39, v222 offset:192
    s_waitcnt lgkmcnt(0)
    v_and_b32 v32, v32, v33
    v_bitop3_b32 v32, v32, v34, v35 bitop3:0x80
    v_cmp_eq_u32 vcc, 0, v32
    s_cbranch_vccnz L_gz
    v_lshlrev_b32 v224, 16, v224
    v_add_f32 v36, v36, v37
    v_add_f32 v38, v38, v39
    v_add_f32 v36, v36, v38
    v_add_f32 v36, v36, v224
    v_cvt_pk_bf16_f32 v36, v36, v36
    s_mov_b32 exec_lo, 0x000f000f
    s_mov_b32 exec_hi, 0x000f000f
    buffer_store_short v36, v223, s[60:63], 0 offen
    s_cmp_eq_u32 s2, 0
    s_cbranch_scc0 L_done
    s_mov_b64 exec, 1
    v_mov_b32 v38, s28
    v_mov_b32 v39, 0
    buffer_store_dword v38, v39, s[44:47], 0 offen sc1
    s_branch L_done
L_C1b:
    v_lshrrev_b32 v25, 1, v2
    v_mul_u32_u24 v25, 320, v25
    v_lshl_add_u32 v25, v1, 4, v25
    v_and_b32 v26, 1, v2
    v_lshl_add_u32 v25, v26, 3, v25
    v_add_u32 v25, 153728, v25
    v_and_b32 v26, 1, v1
    v_mul_u32_u24 v26, 320, v26
    v_lshl_add_u32 v26, v2, 4, v26
    v_add_u32 v26, 153728, v26
    s_mov_b32 s42, 65536
    v_mul_lo_u32 v27, v1, s42
    v_lshl_add_u32 v27, v2, 4, v27
    s_lshr_b32 s42, s40, 4
    s_lshl3_add_u32 s42, s42, s41
    s_and_b32 s43, s40, 15
    s_lshl4_add_u32 s42, s42, s43
    s_mul_i32 s42, s42, 256
    s_add_u32 s100, s42, 393216
    s_lshl_b32 s42, s40, 13
    s_add_u32 s42, s42, 65536
    s_add_u32 s43, s42, 4096
    s_mov_b32 s101, 0x3e0293ee
    v_mov_b32 v15, v7
    v_mov_b32 v19, v7
    v_mov_b32 v22, v7
    v_mov_b32 v23, v7
L_gq0:
    s_sub_u32 s33, s33, 1
    s_cbranch_scc1 L_timeout
    ds_read_b32 v30, v194 offset:0
    s_waitcnt lgkmcnt(0)
    v_cmp_eq_u32 vcc, 0, v30
    s_cbranch_vccnz L_gq0
L_e0:
    s_sub_u32 s33, s33, 64
    s_cbranch_scc1 L_timeout
    buffer_load_dwordx4 v[64:67], v8, s[44:47], s42 offen sc1
    buffer_load_dwordx4 v[68:71], v8, s[44:47], s42 offen offset:1024 sc1
    buffer_load_dwordx4 v[72:75], v8, s[44:47], s42 offen offset:2048 sc1
    buffer_load_dwordx4 v[76:79], v8, s[44:47], s42 offen offset:3072 sc1
    buffer_load_dwordx4 v[80:83], v8, s[44:47], s43 offen sc1
    buffer_load_dwordx4 v[84:87], v8, s[44:47], s43 offen offset:1024 sc1
    buffer_load_dwordx4 v[88:91], v8, s[44:47], s43 offen offset:2048 sc1
    buffer_load_dwordx4 v[92:95], v8, s[44:47], s43 offen offset:3072 sc1
    s_waitcnt vmcnt(7)
    v_xor_b32 v30, s29, v64
    v_bitop3_b32 v30, v65, s30, v30 bitop3:0xbe
    v_bitop3_b32 v30, v66, s31, v30 bitop3:0xbe
    v_bitop3_b32 v30, v67, s32, v30 bitop3:0xbe
    s_waitcnt vmcnt(6)
    v_bitop3_b32 v30, v68, s29, v30 bitop3:0xbe
    v_bitop3_b32 v30, v69, s30, v30 bitop3:0xbe
    v_bitop3_b32 v30, v70, s31, v30 bitop3:0xbe
    v_bitop3_b32 v30, v71, s32, v30 bitop3:0xbe
    v_pk_add_f32 v[64:65], v[64:65], v[68:69]
    v_pk_add_f32 v[66:67], v[66:67], v[70:71]
    s_waitcnt vmcnt(5)
    v_bitop3_b32 v30, v72, s29, v30 bitop3:0xbe
    v_bitop3_b32 v30, v73, s30, v30 bitop3:0xbe
    v_bitop3_b32 v30, v74, s31, v30 bitop3:0xbe
    v_bitop3_b32 v30, v75, s32, v30 bitop3:0xbe
    v_pk_add_f32 v[64:65], v[64:65], v[72:73]
    v_pk_add_f32 v[66:67], v[66:67], v[74:75]
    s_waitcnt vmcnt(4)
    v_bitop3_b32 v30, v76, s29, v30 bitop3:0xbe
    v_bitop3_b32 v30, v77, s30, v30 bitop3:0xbe
    v_bitop3_b32 v30, v78, s31, v30 bitop3:0xbe
    v_bitop3_b32 v30, v79, s32, v30 bitop3:0xbe
    v_pk_add_f32 v[64:65], v[64:65], v[76:77]
    v_pk_add_f32 v[66:67], v[66:67], v[78:79]
    s_waitcnt vmcnt(3)
    v_bitop3_b32 v30, v80, s29, v30 bitop3:0xbe
    v_bitop3_b32 v30, v81, s30, v30 bitop3:0xbe
    v_bitop3_b32 v30, v82, s31, v30 bitop3:0xbe
    v_bitop3_b32 v30, v83, s32, v30 bitop3:0xbe
    v_pk_add_f32 v[64:65], v[64:65], v[80:81]
    v_pk_add_f32 v[66:67], v[66:67], v[82:83]
    s_waitcnt vmcnt(2)
    v_bitop3_b32 v30, v84, s29, v30 bitop3:0xbe
    v_bitop3_b32 v30, v85, s30, v30 bitop3:0xbe
    v_bitop3_b32 v30, v86, s31, v30 bitop3:0xbe
    v_bitop3_b32 v30, v87, s32, v30 bitop3:0xbe
    v_pk_add_f32 v[64:65], v[64:65], v[84:85]
    v_pk_add_f32 v[66:67], v[66:67], v[86:87]
    s_waitcnt vmcnt(1)
    v_bitop3_b32 v30, v88, s29, v30 bitop3:0xbe
    v_bitop3_b32 v30, v89, s30, v30 bitop3:0xbe
    v_bitop3_b32 v30, v90, s31, v30 bitop3:0xbe
    v_bitop3_b32 v30, v91, s32, v30 bitop3:0xbe
    v_pk_add_f32 v[64:65], v[64:65], v[88:89]
    v_pk_add_f32 v[66:67], v[66:67], v[90:91]
    s_waitcnt vmcnt(0)
    v_bitop3_b32 v30, v92, s29, v30 bitop3:0xbe
    v_bitop3_b32 v30, v93, s30, v30 bitop3:0xbe
    v_bitop3_b32 v30, v94, s31, v30 bitop3:0xbe
    v_bitop3_b32 v30, v95, s32, v30 bitop3:0xbe
    v_pk_add_f32 v[64:65], v[64:65], v[92:93]
    v_pk_add_f32 v[66:67], v[66:67], v[94:95]
    v_pk_mul_f32 v[64:65], v[64:65], s[100:101] op_sel:[0,1] op_sel_hi:[1,1]
    v_pk_mul_f32 v[66:67], v[66:67], s[100:101] op_sel:[0,1] op_sel_hi:[1,1]
    v_and_b32 v30, 0xff, v30
    v_cmp_ne_u32 vcc, 0, v30
    s_cbranch_vccnz L_e0
    v_cvt_pk_bf16_f32 v64, v64, v65
    v_cvt_pk_bf16_f32 v65, v66, v67
    ds_write_b64 v25, v[64:65]
    ds_read_b128 v[96:99], v26
    ds_read_b128 v[100:103], v26 offset:64
    ds_read_b128 v[104:107], v26 offset:128
    ds_read_b128 v[108:111], v26 offset:192
    ds_write_b32 v194, v196 offset:8
    s_waitcnt lgkmcnt(4)
    v_mfma_f32_16x16x32_bf16 v[112:115], v[128:131], v[96:99], 0
    v_mfma_f32_16x16x32_bf16 v[116:119], v[144:147], v[96:99], 0
    v_mfma_f32_16x16x32_bf16 v[120:123], v[160:163], v[96:99], 0
    v_mfma_f32_16x16x32_bf16 v[124:127], v[176:179], v[96:99], 0
    s_waitcnt lgkmcnt(3)
    v_mfma_f32_16x16x32_bf16 v[112:115], v[132:135], v[100:103], v[112:115]
    v_mfma_f32_16x16x32_bf16 v[116:119], v[148:151], v[100:103], v[116:119]
    v_mfma_f32_16x16x32_bf16 v[120:123], v[164:167], v[100:103], v[120:123]
    v_mfma_f32_16x16x32_bf16 v[124:127], v[180:183], v[100:103], v[124:127]
    s_waitcnt lgkmcnt(2)
    v_mfma_f32_16x16x32_bf16 v[112:115], v[136:139], v[104:107], v[112:115]
    v_mfma_f32_16x16x32_bf16 v[116:119], v[152:155], v[104:107], v[116:119]
    v_mfma_f32_16x16x32_bf16 v[120:123], v[168:171], v[104:107], v[120:123]
    v_mfma_f32_16x16x32_bf16 v[124:127], v[184:187], v[104:107], v[124:127]
    s_waitcnt lgkmcnt(1)
    v_mfma_f32_16x16x32_bf16 v[112:115], v[140:143], v[108:111], v[112:115]
    v_mfma_f32_16x16x32_bf16 v[116:119], v[156:159], v[108:111], v[116:119]
    v_mfma_f32_16x16x32_bf16 v[120:123], v[172:175], v[108:111], v[120:123]
    v_mfma_f32_16x16x32_bf16 v[124:127], v[188:191], v[108:111], v[124:127]
    s_mov_b32 exec_lo, 0x00030003
    s_mov_b32 exec_hi, 0x00030003
    s_nop 2
    v_cvt_pk_bf16_f32 v12, v112, v113
    v_cvt_pk_bf16_f32 v13, v114, v115
    v_cvt_pk_bf16_f32 v14, v116, v117
    v_cvt_pk_bf16_f32 v20, v118, v119
    v_cvt_pk_bf16_f32 v16, v120, v121
    v_cvt_pk_bf16_f32 v17, v122, v123
    v_cvt_pk_bf16_f32 v18, v124, v125
    v_cvt_pk_bf16_f32 v21, v126, v127
    buffer_store_dwordx4 v[12:15], v27, s[44:47], s100 offen sc1
    buffer_store_dwordx4 v[16:19], v27, s[44:47], s100 offen offset:64 sc1
    buffer_store_dwordx4 v[20:23], v27, s[44:47], s100 offen offset:128 sc1
    s_mov_b64 exec, -1
    ds_write_b32 v194, v196 offset:4
    s_branch L_E1
L_S:
    v_lshlrev_b32 v9, 2, v0
    v_add_u32 v9, 153600, v9
    v_mov_b32 v10, 0
    v_min_u32 v9, 153724, v9
    ds_write_b32 v9, v10
    s_lshr_b32 s42, s38, 2
    s_and_b32 s43, s38, 3
    s_lshr_b32 s96, s39, 1
    s_lshl4_add_u32 s43, s43, s96
    s_lshl_b32 s96, s42, 6
    s_add_u32 s96, s96, s43
    s_lshl2_add_u32 s96, s96, s3
    s_lshl_b32 s96, s96, 15
    s_mul_i32 s97, s3, 33792
    s_mov_b32 m0, s97
    s_movk_i32 s98, 1024
    s_movk_i32 s99, 1056
    s_mov_b32 s100, s42
    s_and_b32 s101, s39, 1
    s_mov_b32 s34, s43
    v_mul_u32_u24 v9, 1056, v1
    v_lshl_add_u32 v9, v2, 4, v9
    v_add_u32 v9, s97, v9
    v_lshlrev_b32 v10, 1, v2
    v_xor_b32 v10, v10, v1
    v_lshlrev_b32 v10, 4, v10
    v_lshl_add_u32 v10, v2, 8, v10
    v_add_u32 v10, 135168, v10
    v_lshrrev_b32 v11, 2, v0
    v_mul_u32_u24 v11, 1056, v11
    v_and_b32 v12, 3, v0
    v_lshl_add_u32 v11, v12, 3, v11
    s_lshl_b32 s42, s3, 8
    v_add_u32 v11, s42, v11
    v_add_u32 v12, 67584, v11
    v_add_u32 v14, 135168, v8
    s_lshl_b32 s42, s3, 10
    v_add_u32 v13, s42, v14
    v_lshlrev_b32 v16, 4, v1
    v_add_u32 v16, 154304, v16
    s_lshl_b32 s42, s3, 2
    v_add_u32 v15, s42, v16
    v_mov_b32 v17, 153600
    v_mov_b32 v18, 1
    v_add_u32 v19, s42, v17
    v_lshlrev_b32 v20, 19, v2
    v_lshrrev_b32 v22, 3, v1
    v_lshl_add_u32 v20, v22, 14, v20
    v_and_b32 v22, 7, v1
    v_lshl_add_u32 v20, v22, 4, v20
    s_lshl_b32 s42, s101, 21
    s_lshl_b32 s43, s3, 15
    s_add_u32 s42, s42, s43
    s_lshl_b32 s43, s100, 13
    s_add_u32 s42, s42, s43
    s_lshl_b32 s43, s34, 7
    s_add_u32 s42, s42, s43
    s_add_u32 s42, s42, 1048576
    v_add_u32 v20, s42, v20
    v_min_u32 v23, 1, v2
    v_lshlrev_b32 v22, 4, v1
    v_lshl_add_u32 v21, v23, 31, v22
    s_lshl_b32 s42, s101, 17
    s_lshl_b32 s43, s3, 15
    s_add_u32 s42, s42, s43
    s_lshl_b32 s43, s100, 14
    s_add_u32 s42, s42, s43
    s_lshl_b32 s43, s34, 8
    s_add_u32 s42, s42, s43
    s_add_u32 s42, s42, 524288
    v_add_u32 v21, s42, v21
    s_waitcnt lgkmcnt(0)
    s_mov_b32 s48, s6
    s_and_b32 s49, s7, 0xffff
    s_mov_b32 s50, 16777216
    s_mov_b32 s51, 0x00020000
    s_barrier
    buffer_load_dwordx4 v8, s[48:51], s96 offen nt lds
    s_add_u32 m0, m0, s99
    s_add_u32 s96, s96, s98
    buffer_load_dwordx4 v8, s[48:51], s96 offen nt lds
    s_add_u32 m0, m0, s99
    s_add_u32 s96, s96, s98
    buffer_load_dwordx4 v8, s[48:51], s96 offen nt lds
    s_add_u32 m0, m0, s99
    s_add_u32 s96, s96, s98
    buffer_load_dwordx4 v8, s[48:51], s96 offen nt lds
    s_add_u32 m0, m0, s99
    s_add_u32 s96, s96, s98
    buffer_load_dwordx4 v8, s[48:51], s96 offen nt lds
    s_add_u32 m0, m0, s99
    s_add_u32 s96, s96, s98
    s_load_dword s28, s[26:27], 0
    s_mov_b32 s44, s26
    s_and_b32 s45, s27, 0xffff
    s_mov_b32 s46, 9437184
    s_mov_b32 s47, 0x00020000
    s_movk_i32 s42, 27
L_dmaA:
    ds_read_b32 v22, v17 offset:8
    s_waitcnt vmcnt(4)
    buffer_load_dwordx4 v8, s[48:51], s96 offen nt lds
    s_add_u32 m0, m0, s99
    s_add_u32 s96, s96, s98
    s_sub_u32 s42, s42, 1
    s_cmp_eq_u32 s42, 0
    s_cbranch_scc1 L_dmaE
    s_waitcnt lgkmcnt(0)
    v_cmp_eq_u32 vcc, 0, v22
    s_cbranch_vccnz L_dmaA
L_dmaB:
    s_waitcnt vmcnt(15)
    buffer_load_dwordx4 v8, s[48:51], s96 offen nt lds
    s_add_u32 m0, m0, s99
    s_add_u32 s96, s96, s98
    s_sub_u32 s42, s42, 1
    s_cmp_lg_u32 s42, 0
    s_cbranch_scc1 L_dmaB
L_dmaE:
    ds_write_b32 v19, v18 offset:64
    s_waitcnt vmcnt(16)
    ds_read_b128 v[128:131], v9
    ds_read_b128 v[136:139], v9 offset:64
    ds_read_b128 v[144:147], v9 offset:128
    ds_read_b128 v[152:155], v9 offset:192
    ds_read_b128 v[160:163], v9 offset:256
    ds_read_b128 v[168:171], v9 offset:320
    ds_read_b128 v[176:179], v9 offset:384
    ds_read_b128 v[184:187], v9 offset:448
    ds_read_b128 v[192:195], v9 offset:512
    ds_read_b128 v[200:203], v9 offset:576
    ds_read_b128 v[208:211], v9 offset:640
    ds_read_b128 v[216:219], v9 offset:704
    ds_read_b128 v[224:227], v9 offset:768
    ds_read_b128 v[232:235], v9 offset:832
    ds_read_b128 v[240:243], v9 offset:896
    ds_read_b128 v[248:251], v9 offset:960
    s_waitcnt vmcnt(0)
    ds_read_b128 v[132:135], v9 offset:16896
    ds_read_b128 v[140:143], v9 offset:16960
    ds_read_b128 v[148:151], v9 offset:17024
    ds_read_b128 v[156:159], v9 offset:17088
    ds_read_b128 v[164:167], v9 offset:17152
    ds_read_b128 v[172:175], v9 offset:17216
    ds_read_b128 v[180:183], v9 offset:17280
    ds_read_b128 v[188:191], v9 offset:17344
    ds_read_b128 v[196:199], v9 offset:17408
    ds_read_b128 v[204:207], v9 offset:17472
    ds_read_b128 v[212:215], v9 offset:17536
    ds_read_b128 v[220:223], v9 offset:17600
    ds_read_b128 v[228:231], v9 offset:17664
    ds_read_b128 v[236:239], v9 offset:17728
    ds_read_b128 v[244:247], v9 offset:17792
    ds_read_b128 v[252:255], v9 offset:17856
    s_waitcnt lgkmcnt(0)
    s_add_u32 s28, s28, 1
    s_mul_i32 s29, s28, 0x9E3779B1
    s_lshr_b32 s30, s29, 8
    s_lshr_b32 s31, s29, 16
    s_lshr_b32 s32, s29, 24
    v_mov_b32 v7, s29
    s_mul_i32 s42, s34, 0x9E3779B1
    s_xor_b32 s42, s42, s29
    v_and_b32 v22, 3, v1
    v_lshlrev_b32 v22, 2, v22
    v_lshrrev_b32 v22, v22, s42
    v_lshrrev_b32 v24, 0, v22
    v_and_b32 v24, 0x00010001, v24
    v_lshrrev_b32 v25, 1, v22
    v_and_b32 v25, 0x00010001, v25
    v_lshrrev_b32 v26, 2, v22
    v_and_b32 v26, 0x00010001, v26
    v_lshrrev_b32 v27, 3, v22
    v_and_b32 v27, 0x00010001, v27
    s_mov_b32 s42, 0xfffefffe
    s_barrier
    s_setprio 1
    ds_read_b128 v[64:67], v10
    ds_read_b128 v[68:71], v10 offset:1024
    ds_read_b128 v[72:75], v10 offset:2048
    ds_read_b128 v[76:79], v10 offset:3072
    ds_read_b128 v[80:83], v10 offset:4096
    ds_read_b128 v[84:87], v10 offset:5120
    ds_read_b128 v[88:91], v10 offset:6144
    ds_read_b128 v[92:95], v10 offset:7168
    s_waitcnt lgkmcnt(7)
    v_mfma_f32_16x16x32_bf16 v[40:43], v[128:131], v[64:67], 0
    v_mfma_f32_16x16x32_bf16 v[44:47], v[132:135], v[64:67], 0
    ds_read_b128 v[96:99], v10 offset:8192
    s_waitcnt lgkmcnt(7)
    v_mfma_f32_16x16x32_bf16 v[40:43], v[136:139], v[68:71], v[40:43]
    v_mfma_f32_16x16x32_bf16 v[44:47], v[140:143], v[68:71], v[44:47]
    ds_read_b128 v[100:103], v10 offset:9216
    s_waitcnt lgkmcnt(7)
    v_mfma_f32_16x16x32_bf16 v[40:43], v[144:147], v[72:75], v[40:43]
    v_mfma_f32_16x16x32_bf16 v[44:47], v[148:151], v[72:75], v[44:47]
    ds_read_b128 v[104:107], v10 offset:10240
    s_waitcnt lgkmcnt(7)
    v_mfma_f32_16x16x32_bf16 v[40:43], v[152:155], v[76:79], v[40:43]
    v_mfma_f32_16x16x32_bf16 v[44:47], v[156:159], v[76:79], v[44:47]
    ds_read_b128 v[108:111], v10 offset:11264
    s_waitcnt lgkmcnt(7)
    v_mfma_f32_16x16x32_bf16 v[40:43], v[160:163], v[80:83], v[40:43]
    v_mfma_f32_16x16x32_bf16 v[44:47], v[164:167], v[80:83], v[44:47]
    ds_read_b128 v[112:115], v10 offset:12288
    s_waitcnt lgkmcnt(7)
    v_mfma_f32_16x16x32_bf16 v[40:43], v[168:171], v[84:87], v[40:43]
    v_mfma_f32_16x16x32_bf16 v[44:47], v[172:175], v[84:87], v[44:47]
    ds_read_b128 v[116:119], v10 offset:13312
    s_waitcnt lgkmcnt(7)
    v_mfma_f32_16x16x32_bf16 v[40:43], v[176:179], v[88:91], v[40:43]
    v_mfma_f32_16x16x32_bf16 v[44:47], v[180:183], v[88:91], v[44:47]
    ds_read_b128 v[120:123], v10 offset:14336
    s_waitcnt lgkmcnt(7)
    v_mfma_f32_16x16x32_bf16 v[40:43], v[184:187], v[92:95], v[40:43]
    v_mfma_f32_16x16x32_bf16 v[44:47], v[188:191], v[92:95], v[44:47]
    ds_read_b128 v[124:127], v10 offset:15360
    s_waitcnt lgkmcnt(7)
    v_mfma_f32_16x16x32_bf16 v[40:43], v[192:195], v[96:99], v[40:43]
    v_mfma_f32_16x16x32_bf16 v[44:47], v[196:199], v[96:99], v[44:47]
    ds_read_b64_tr_b16 v[128:129], v11
    ds_read_b64_tr_b16 v[130:131], v11 offset:16896
    ds_read_b64_tr_b16 v[132:133], v11 offset:32
    ds_read_b64_tr_b16 v[134:135], v11 offset:16928
    s_waitcnt lgkmcnt(10)
    v_mfma_f32_16x16x32_bf16 v[40:43], v[200:203], v[100:103], v[40:43]
    v_mfma_f32_16x16x32_bf16 v[44:47], v[204:207], v[100:103], v[44:47]
    ds_read_b64_tr_b16 v[136:137], v11 offset:64
    ds_read_b64_tr_b16 v[138:139], v11 offset:16960
    ds_read_b64_tr_b16 v[140:141], v11 offset:96
    ds_read_b64_tr_b16 v[142:143], v11 offset:16992
    s_waitcnt lgkmcnt(13)
    v_mfma_f32_16x16x32_bf16 v[40:43], v[208:211], v[104:107], v[40:43]
    v_mfma_f32_16x16x32_bf16 v[44:47], v[212:215], v[104:107], v[44:47]
    ds_read_b64_tr_b16 v[144:145], v11 offset:128
    ds_read_b64_tr_b16 v[146:147], v11 offset:17024
    ds_read_b64_tr_b16 v[148:149], v11 offset:160
    ds_read_b64_tr_b16 v[150:151], v11 offset:17056
    s_waitcnt lgkmcnt(15)
    v_mfma_f32_16x16x32_bf16 v[40:43], v[216:219], v[108:111], v[40:43]
    v_mfma_f32_16x16x32_bf16 v[44:47], v[220:223], v[108:111], v[44:47]
    ds_read_b64_tr_b16 v[152:153], v11 offset:192
    ds_read_b64_tr_b16 v[154:155], v11 offset:17088
    ds_read_b64_tr_b16 v[156:157], v11 offset:224
    ds_read_b64_tr_b16 v[158:159], v11 offset:17120
    v_mfma_f32_16x16x32_bf16 v[40:43], v[224:227], v[112:115], v[40:43]
    v_mfma_f32_16x16x32_bf16 v[44:47], v[228:231], v[112:115], v[44:47]
    ds_read_b64_tr_b16 v[160:161], v11 offset:33792
    ds_read_b64_tr_b16 v[162:163], v11 offset:50688
    ds_read_b64_tr_b16 v[164:165], v11 offset:33824
    ds_read_b64_tr_b16 v[166:167], v11 offset:50720
    s_waitcnt lgkmcnt(15)
    v_mfma_f32_16x16x32_bf16 v[40:43], v[232:235], v[116:119], v[40:43]
    v_mfma_f32_16x16x32_bf16 v[44:47], v[236:239], v[116:119], v[44:47]
    ds_read_b64_tr_b16 v[168:169], v11 offset:33856
    ds_read_b64_tr_b16 v[170:171], v11 offset:50752
    ds_read_b64_tr_b16 v[172:173], v11 offset:33888
    ds_read_b64_tr_b16 v[174:175], v11 offset:50784
    v_mfma_f32_16x16x32_bf16 v[40:43], v[240:243], v[120:123], v[40:43]
    v_mfma_f32_16x16x32_bf16 v[44:47], v[244:247], v[120:123], v[44:47]
    ds_read_b64_tr_b16 v[176:177], v11 offset:33920
    ds_read_b64_tr_b16 v[178:179], v11 offset:50816
    ds_read_b64_tr_b16 v[180:181], v11 offset:33952
    ds_read_b64_tr_b16 v[182:183], v11 offset:50848
    v_mfma_f32_16x16x32_bf16 v[40:43], v[248:251], v[124:127], v[40:43]
    v_mfma_f32_16x16x32_bf16 v[44:47], v[252:255], v[124:127], v[44:47]
    ds_read_b64_tr_b16 v[184:185], v11 offset:33984
    ds_read_b64_tr_b16 v[186:187], v11 offset:50880
    ds_read_b64_tr_b16 v[188:189], v11 offset:34016
    ds_read_b64_tr_b16 v[190:191], v11 offset:50912
    s_nop 2
    v_max3_f32 v60, v40, v41, v42
    v_max3_f32 v61, v43, v44, v45
    v_max3_f32 v60, v60, v46, v47
    v_max_f32 v60, v60, v61
    v_mov_b32 v61, v60
    s_nop 1
    v_permlane16_swap_b32 v60, v61
    v_max_f32 v60, v60, v61
    v_mov_b32 v61, v60
    s_nop 1
    v_permlane32_swap_b32 v60, v61
    v_max_f32 v60, v60, v61
    ds_write_b32 v15, v60
    s_waitcnt lgkmcnt(0)
    s_barrier
    ds_read_b128 v[60:63], v16
    ds_read_b64_tr_b16 v[192:193], v12
    ds_read_b64_tr_b16 v[194:195], v12 offset:16896
    ds_read_b64_tr_b16 v[196:197], v12 offset:32
    ds_read_b64_tr_b16 v[198:199], v12 offset:16928
    ds_read_b64_tr_b16 v[200:201], v12 offset:64
    ds_read_b64_tr_b16 v[202:203], v12 offset:16960
    ds_read_b64_tr_b16 v[204:205], v12 offset:96
    ds_read_b64_tr_b16 v[206:207], v12 offset:16992
    ds_read_b64_tr_b16 v[208:209], v12 offset:128
    ds_read_b64_tr_b16 v[210:211], v12 offset:17024
    ds_read_b64_tr_b16 v[212:213], v12 offset:160
    ds_read_b64_tr_b16 v[214:215], v12 offset:17056
    s_waitcnt lgkmcnt(12)
    v_max3_f32 v60, v60, v61, v62
    v_max_f32 v116, v60, v63
    v_pk_add_f32 v[40:41], v[40:41], v[116:117] op_sel_hi:[1,0] neg_lo:[0,1] neg_hi:[0,1]
    v_pk_add_f32 v[42:43], v[42:43], v[116:117] op_sel_hi:[1,0] neg_lo:[0,1] neg_hi:[0,1]
    v_pk_add_f32 v[44:45], v[44:45], v[116:117] op_sel_hi:[1,0] neg_lo:[0,1] neg_hi:[0,1]
    v_pk_add_f32 v[46:47], v[46:47], v[116:117] op_sel_hi:[1,0] neg_lo:[0,1] neg_hi:[0,1]
    v_exp_f32 v40, v40
    v_exp_f32 v41, v41
    v_exp_f32 v42, v42
    v_exp_f32 v43, v43
    v_exp_f32 v44, v44
    v_exp_f32 v45, v45
    v_exp_f32 v46, v46
    v_exp_f32 v47, v47
    v_cvt_pk_bf16_f32 v40, v40, v41
    v_cvt_pk_bf16_f32 v41, v42, v43
    v_cvt_pk_bf16_f32 v42, v44, v45
    v_cvt_pk_bf16_f32 v43, v46, v47
    ds_write_b128 v13, v[40:43]
    v_mov_b32 v120, 0x3f803f80
    v_mov_b32 v121, 0x3f803f80
    v_mov_b32 v122, 0x3f803f80
    v_mov_b32 v123, 0x3f803f80
    s_waitcnt lgkmcnt(0)
    s_barrier
    ds_read_b128 v[64:67], v14
    ds_read_b128 v[68:71], v14 offset:1024
    ds_read_b128 v[72:75], v14 offset:2048
    ds_read_b128 v[76:79], v14 offset:3072
    ds_read_b64_tr_b16 v[216:217], v12 offset:192
    ds_read_b64_tr_b16 v[218:219], v12 offset:17088
    ds_read_b64_tr_b16 v[220:221], v12 offset:224
    ds_read_b64_tr_b16 v[222:223], v12 offset:17120
    ds_read_b64_tr_b16 v[224:225], v12 offset:33792
    ds_read_b64_tr_b16 v[226:227], v12 offset:50688
    ds_read_b64_tr_b16 v[228:229], v12 offset:33824
    ds_read_b64_tr_b16 v[230:231], v12 offset:50720
    ds_read_b64_tr_b16 v[232:233], v12 offset:33856
    ds_read_b64_tr_b16 v[234:235], v12 offset:50752
    ds_read_b64_tr_b16 v[236:237], v12 offset:33888
    ds_read_b64_tr_b16 v[238:239], v12 offset:50784
    ds_read_b64_tr_b16 v[240:241], v12 offset:33920
    ds_read_b64_tr_b16 v[242:243], v12 offset:50816
    ds_read_b64_tr_b16 v[244:245], v12 offset:33952
    ds_read_b64_tr_b16 v[246:247], v12 offset:50848
    ds_read_b64_tr_b16 v[248:249], v12 offset:33984
    ds_read_b64_tr_b16 v[250:251], v12 offset:50880
    ds_read_b64_tr_b16 v[252:253], v12 offset:34016
    ds_read_b64_tr_b16 v[254:255], v12 offset:50912
    s_mov_b32 s43, 131072
    s_mov_b32 s96, 262144
    s_mov_b32 s97, 393216
    v_mov_b32 v118, v7
    v_mov_b32 v119, v7
    s_waitcnt lgkmcnt(15)
    v_mfma_f32_16x16x32_bf16 v[112:115], v[120:123], v[64:67], 0
    v_mfma_f32_16x16x32_bf16 v[80:83], v[64:67], v[128:131], 0
    v_mfma_f32_16x16x32_bf16 v[84:87], v[64:67], v[132:135], 0
    v_mfma_f32_16x16x32_bf16 v[88:91], v[64:67], v[136:139], 0
    v_mfma_f32_16x16x32_bf16 v[92:95], v[64:67], v[140:143], 0
    v_mfma_f32_16x16x32_bf16 v[96:99], v[64:67], v[144:147], 0
    v_mfma_f32_16x16x32_bf16 v[100:103], v[64:67], v[148:151], 0
    v_mfma_f32_16x16x32_bf16 v[104:107], v[64:67], v[152:155], 0
    v_mfma_f32_16x16x32_bf16 v[108:111], v[64:67], v[156:159], 0
    v_mfma_f32_16x16x32_bf16 v[112:115], v[120:123], v[68:71], v[112:115]
    v_mfma_f32_16x16x32_bf16 v[80:83], v[68:71], v[160:163], v[80:83]
    v_mfma_f32_16x16x32_bf16 v[84:87], v[68:71], v[164:167], v[84:87]
    v_mfma_f32_16x16x32_bf16 v[88:91], v[68:71], v[168:171], v[88:91]
    v_mfma_f32_16x16x32_bf16 v[92:95], v[68:71], v[172:175], v[92:95]
    v_mfma_f32_16x16x32_bf16 v[96:99], v[68:71], v[176:179], v[96:99]
    v_mfma_f32_16x16x32_bf16 v[100:103], v[68:71], v[180:183], v[100:103]
    v_mfma_f32_16x16x32_bf16 v[104:107], v[68:71], v[184:187], v[104:107]
    v_mfma_f32_16x16x32_bf16 v[108:111], v[68:71], v[188:191], v[108:111]
    v_mfma_f32_16x16x32_bf16 v[112:115], v[120:123], v[72:75], v[112:115]
    v_mfma_f32_16x16x32_bf16 v[80:83], v[72:75], v[192:195], v[80:83]
    v_mfma_f32_16x16x32_bf16 v[84:87], v[72:75], v[196:199], v[84:87]
    v_mfma_f32_16x16x32_bf16 v[88:91], v[72:75], v[200:203], v[88:91]
    v_mfma_f32_16x16x32_bf16 v[92:95], v[72:75], v[204:207], v[92:95]
    v_mfma_f32_16x16x32_bf16 v[96:99], v[72:75], v[208:211], v[96:99]
    v_mfma_f32_16x16x32_bf16 v[100:103], v[72:75], v[212:215], v[100:103]
    v_mfma_f32_16x16x32_bf16 v[104:107], v[72:75], v[216:219], v[104:107]
    v_mfma_f32_16x16x32_bf16 v[108:111], v[72:75], v[220:223], v[108:111]
    v_mfma_f32_16x16x32_bf16 v[112:115], v[120:123], v[76:79], v[112:115]
    s_waitcnt lgkmcnt(14)
    v_mfma_f32_16x16x32_bf16 v[80:83], v[76:79], v[224:227], v[80:83]
    s_waitcnt lgkmcnt(12)
    v_mfma_f32_16x16x32_bf16 v[84:87], v[76:79], v[228:231], v[84:87]
    s_waitcnt lgkmcnt(10)
    v_mfma_f32_16x16x32_bf16 v[88:91], v[76:79], v[232:235], v[88:91]
    s_waitcnt lgkmcnt(8)
    v_mfma_f32_16x16x32_bf16 v[92:95], v[76:79], v[236:239], v[92:95]
    s_waitcnt lgkmcnt(6)
    v_mfma_f32_16x16x32_bf16 v[96:99], v[76:79], v[240:243], v[96:99]
    s_waitcnt lgkmcnt(4)
    v_mfma_f32_16x16x32_bf16 v[100:103], v[76:79], v[244:247], v[100:103]
    s_waitcnt lgkmcnt(2)
    v_mfma_f32_16x16x32_bf16 v[104:107], v[76:79], v[248:251], v[104:107]
    s_waitcnt lgkmcnt(0)
    v_mfma_f32_16x16x32_bf16 v[108:111], v[76:79], v[252:255], v[108:111]
    v_mov_b32 v117, v112
    buffer_store_dwordx4 v[116:119], v21, s[44:47], 0 offen sc1
    v_cvt_pk_bf16_f32 v64, v80, v84
    v_cvt_pk_bf16_f32 v65, v88, v92
    v_cvt_pk_bf16_f32 v66, v96, v100
    s_nop 2
    v_cvt_pk_bf16_f32 v67, v104, v108
    v_and_or_b32 v64, v64, s42, v24
    v_and_or_b32 v65, v65, s42, v25
    v_and_or_b32 v66, v66, s42, v26
    v_and_or_b32 v67, v67, s42, v27
    buffer_store_dwordx4 v[64:67], v20, s[44:47], 0 offen sc1
    v_cvt_pk_bf16_f32 v68, v81, v85
    v_cvt_pk_bf16_f32 v69, v89, v93
    v_cvt_pk_bf16_f32 v70, v97, v101
    v_cvt_pk_bf16_f32 v71, v105, v109
    v_and_or_b32 v68, v68, s42, v24
    v_and_or_b32 v69, v69, s42, v25
    v_and_or_b32 v70, v70, s42, v26
    v_and_or_b32 v71, v71, s42, v27
    buffer_store_dwordx4 v[68:71], v20, s[44:47], s43 offen sc1
    v_cvt_pk_bf16_f32 v72, v82, v86
    v_cvt_pk_bf16_f32 v73, v90, v94
    v_cvt_pk_bf16_f32 v74, v98, v102
    v_cvt_pk_bf16_f32 v75, v106, v110
    v_and_or_b32 v72, v72, s42, v24
    v_and_or_b32 v73, v73, s42, v25
    v_and_or_b32 v74, v74, s42, v26
    v_and_or_b32 v75, v75, s42, v27
    buffer_store_dwordx4 v[72:75], v20, s[44:47], s96 offen sc1
    v_cvt_pk_bf16_f32 v76, v83, v87
    v_cvt_pk_bf16_f32 v77, v91, v95
    v_cvt_pk_bf16_f32 v78, v99, v103
    v_cvt_pk_bf16_f32 v79, v107, v111
    v_and_or_b32 v76, v76, s42, v24
    v_and_or_b32 v77, v77, s42, v25
    v_and_or_b32 v78, v78, s42, v26
    v_and_or_b32 v79, v79, s42, v27
    buffer_store_dwordx4 v[76:79], v20, s[44:47], s97 offen sc1
    ds_write_b32 v19, v18 offset:96
    v_lshrrev_b32 v30, 3, v1
    v_and_b32 v31, 7, v1
    s_lshr_b32 s99, s2, 1
    s_mul_i32 s99, s99, 36
    s_and_b32 s101, s2, 1
    s_mul_i32 s42, s101, 20
    s_add_u32 s99, s99, s42
    v_lshl_add_u32 v204, v2, 2, s99
    v_lshrrev_b32 v32, 7, v204
    v_mul_u32_u24 v32, 6, v32
    v_min_u32 v33, 5, v31
    v_add_lshl_u32 v32, v32, v33, 10
    v_lshl_add_u32 v32, v30, 9, v32
    v_bfe_u32 v33, v204, 2, 1
    v_lshl_add_u32 v32, v33, 8, v32
    v_bfe_u32 v33, v204, 3, 4
    v_lshl_add_u32 v204, v33, 4, v32
    s_cmp_eq_u32 s101, 0
    s_cselect_b32 s42, 16, 12
    s_add_u32 s42, s42, s99
    v_mov_b32 v205, s42
    v_lshrrev_b32 v32, 7, v205
    v_mul_u32_u24 v32, 6, v32
    v_min_u32 v33, 5, v31
    v_add_lshl_u32 v32, v32, v33, 10
    v_lshl_add_u32 v32, v30, 9, v32
    v_bfe_u32 v33, v205, 2, 1
    v_lshl_add_u32 v32, v33, 8, v32
    v_bfe_u32 v33, v205, 3, 4
    v_lshl_add_u32 v205, v33, 4, v32
    s_mov_b32 s42, 5505024
    v_lshl_add_u32 v205, v2, 2, v205
    v_add_u32 v205, s42, v205
    v_add_u32 v204, s42, v204
    v_lshlrev_b32 v32, 3, v2
    v_lshrrev_b32 v206, v32, v7
    v_cmp_le_u32 vcc, 6, v31
    s_nop 1
    v_cndmask_b32_e64 v207, -1, 0, vcc
    v_add_u32 v208, 151552, v8
    v_lshlrev_b32 v32, 2, v0
    v_add_u32 v209, 152576, v32
    s_waitcnt vmcnt(0)
    ds_write_b32 v19, v18 offset:16
    s_cmp_eq_u32 s3, 0
    s_cbranch_scc0 L_done
L_ghx:
    s_sub_u32 s33, s33, 1
    s_cbranch_scc1 L_timeout
    ds_read_b32 v32, v17 offset:80
    s_waitcnt lgkmcnt(0)
    v_cmp_eq_u32 vcc, 0, v32
    s_cbranch_vccnz L_ghx
    buffer_load_dwordx4 v[12:15], v204, s[44:47], 0 offen sc1
    buffer_load_dword v16, v205, s[44:47], 0 offen sc1
    s_waitcnt vmcnt(0)
L_eh:
    v_xor_b32 v30, s29, v12
    v_bitop3_b32 v30, v13, s30, v30 bitop3:0xbe
    v_bitop3_b32 v30, v14, s31, v30 bitop3:0xbe
    v_bitop3_b32 v30, v15, s32, v30 bitop3:0xbe
    v_bitop3_b32 v30, v16, v206, v30 bitop3:0xbe
    v_and_b32 v30, 0xff, v30
    v_cmp_ne_u32 vcc, 0, v30
    s_cbranch_vccz L_okH
    s_sub_u32 s33, s33, 64
    s_cbranch_scc1 L_timeout
    buffer_load_dwordx4 v[12:15], v204, s[44:47], 0 offen sc1
    buffer_load_dword v16, v205, s[44:47], 0 offen sc1
    s_waitcnt vmcnt(0)
    s_branch L_eh
L_okH:
    v_and_b32 v12, v12, v207
    v_and_b32 v13, v13, v207
    v_and_b32 v14, v14, v207
    v_and_b32 v15, v15, v207
    v_and_b32 v16, v16, v207
    v_add_f32_dpp v12, v12, v12 quad_perm:[1,0,3,2] row_mask:0xf bank_mask:0xf
    v_add_f32_dpp v13, v13, v13 quad_perm:[1,0,3,2] row_mask:0xf bank_mask:0xf
    v_add_f32_dpp v14, v14, v14 quad_perm:[1,0,3,2] row_mask:0xf bank_mask:0xf
    v_add_f32_dpp v15, v15, v15 quad_perm:[1,0,3,2] row_mask:0xf bank_mask:0xf
    v_add_f32_dpp v16, v16, v16 quad_perm:[1,0,3,2] row_mask:0xf bank_mask:0xf
    v_add_f32_dpp v12, v12, v12 quad_perm:[2,3,0,1] row_mask:0xf bank_mask:0xf
    v_add_f32_dpp v13, v13, v13 quad_perm:[2,3,0,1] row_mask:0xf bank_mask:0xf
    v_add_f32_dpp v14, v14, v14 quad_perm:[2,3,0,1] row_mask:0xf bank_mask:0xf
    v_add_f32_dpp v15, v15, v15 quad_perm:[2,3,0,1] row_mask:0xf bank_mask:0xf
    v_add_f32_dpp v16, v16, v16 quad_perm:[2,3,0,1] row_mask:0xf bank_mask:0xf
    v_add_f32_dpp v12, v12, v12 row_half_mirror row_mask:0xf bank_mask:0xf
    v_add_f32_dpp v13, v13, v13 row_half_mirror row_mask:0xf bank_mask:0xf
    v_add_f32_dpp v14, v14, v14 row_half_mirror row_mask:0xf bank_mask:0xf
    v_add_f32_dpp v15, v15, v15 row_half_mirror row_mask:0xf bank_mask:0xf
    v_add_f32_dpp v16, v16, v16 row_half_mirror row_mask:0xf bank_mask:0xf
    v_cvt_pk_bf16_f32 v12, 0, v12
    v_cvt_pk_bf16_f32 v13, 0, v13
    v_cvt_pk_bf16_f32 v14, 0, v14
    v_cvt_pk_bf16_f32 v15, 0, v15
    v_cvt_pk_bf16_f32 v16, 0, v16
    v_mul_f32 v32, 0xbfb8aa3b, v12
    v_mul_f32 v33, 0xbfb8aa3b, v13
    v_mul_f32 v34, 0xbfb8aa3b, v14
    v_mul_f32 v35, 0xbfb8aa3b, v15
    v_mul_f32 v36, 0xbfb8aa3b, v16
    v_exp_f32 v32, v32
    v_exp_f32 v33, v33
    v_exp_f32 v34, v34
    v_exp_f32 v35, v35
    v_exp_f32 v36, v36
    v_add_f32 v32, 1.0, v32
    v_add_f32 v33, 1.0, v33
    v_add_f32 v34, 1.0, v34
    v_add_f32 v35, 1.0, v35
    v_add_f32 v36, 1.0, v36
    v_rcp_f32 v32, v32
    v_rcp_f32 v33, v33
    v_rcp_f32 v34, v34
    v_rcp_f32 v35, v35
    v_rcp_f32 v36, v36
    v_mul_f32 v12, v12, v32
    v_mul_f32 v13, v13, v33
    v_mul_f32 v14, v14, v34
    v_mul_f32 v15, v15, v35
    v_mul_f32 v16, v16, v36
    v_cvt_pk_bf16_f32 v12, v12, v12
    v_cvt_pk_bf16_f32 v13, v13, v13
    v_cvt_pk_bf16_f32 v14, v14, v14
    v_cvt_pk_bf16_f32 v15, v15, v15
    v_cvt_pk_bf16_f32 v16, v16, v16
    ds_write_b128 v208, v[12:15]
    ds_write_b32 v209, v16
    ds_write_b32 v17, v18 offset:12
L_done:
L_exit:
    s_endpgm
L_timeout:
    s_endpgm
L_codeend:

.section .rodata,"a"
.p2align 6
.amdhsa_kernel parallel_sum__compressed_kv_cla__dense_activation_silu__decode_kernel
  .amdhsa_next_free_vgpr 256
  .amdhsa_next_free_sgpr 102
  .amdhsa_accum_offset 256
  .amdhsa_group_segment_fixed_size 0
  .amdhsa_kernarg_size 96
  .amdhsa_user_sgpr_count 2
  .amdhsa_user_sgpr_kernarg_segment_ptr 1
  .amdhsa_system_sgpr_workgroup_id_x 1
.end_amdhsa_kernel
.text
```
